```python
import torch

def _softmax(x, axis=-1):
    return torch.softmax(x, dim=axis)
def _gelu(x):
    return torch.nn.functional.gelu(x, approximate="tanh")
def _silu(x):
    return torch.nn.functional.silu(x)
def _sigmoid(x):
    return torch.sigmoid(x)
def _layernorm(x, axis=-1, eps=1e-5):
    m = x.mean(dim=axis, keepdim=True)
    v = x.var(dim=axis, keepdim=True, unbiased=False)
    return (x - m) / torch.sqrt(v + eps)
def _scatter_add(tgt, idx, src, axis=0):
    return tgt.clone().index_add_(axis, idx, src)
def _segment_sum(src, seg, n):
    out = torch.zeros((n,) + src.shape[1:], dtype=src.dtype)
    return out.index_add_(0, seg, src)
def _pad(x, pw):
    flat = tuple(v for pair in reversed(pw) for v in pair)
    return torch.nn.functional.pad(x, flat)

kernel_name = 'gated_mix__linear_kernel_hedgehog__dense_activation_gelu__prompt'

def setup_inputs():

    _w = (lambda a: (lambda t: t.to(torch.bfloat16) if t.is_floating_point() else t)(torch.as_tensor(a)))
    def _A_setup():
        B, S, D, H = 1, 2048, 448, 16
        Dh = D // H
        return {
            "x": _w((lambda *s: torch.randn(*s, dtype=torch.bfloat16) * 0.05)(B, S, D)),
            "wqkv": _w((lambda *s: torch.randn(*s, dtype=torch.bfloat16) * 0.8)(D, 3 * D)),
            "w_phi": _w((lambda *s: torch.randn(*s, dtype=torch.bfloat16) * 0.8)(H, Dh, Dh) * (Dh ** -0.5)),
            "wo": _w((lambda *s: torch.randn(*s, dtype=torch.bfloat16) * 0.05)(D, D)),
        }
    _A_in = _A_setup()

    def _B_setup():
        B, S, D, F = 1, 2048, 448, 1792
        return {
            "x": _w((lambda *s: torch.randn(*s, dtype=torch.bfloat16) * 0.05)(B, S, D)),
            "w1": _w((lambda *s: torch.randn(*s, dtype=torch.bfloat16) * 3.2)(D, F) * (D ** -0.5)),
            "b1": _w((lambda *s: torch.randn(*s, dtype=torch.bfloat16) * 3.2)(F) * 0.01),
            "w2": _w((lambda *s: torch.randn(*s, dtype=torch.bfloat16) * 0.2)(F, D) * (F ** -0.5)),
            "b2": _w((lambda *s: torch.randn(*s, dtype=torch.bfloat16) * 0.4)(D) * 0.01),
        }
    _B_in = _B_setup()

    return {
        "A_x": _A_in["x"],
        "A_wqkv": _A_in["wqkv"],
        "A_w_phi": _A_in["w_phi"],
        "A_wo": _A_in["wo"],
        "B_x": _B_in["x"],
        "B_w1": _B_in["w1"],
        "B_b1": _B_in["b1"],
        "B_w2": _B_in["w2"],
        "B_b2": _B_in["b2"],
        "gate_w": _w((lambda *s: torch.randn(*s, dtype=torch.bfloat16) * 0.05)(448) * 16.0),
    }

def reference(A_x, A_wqkv, A_w_phi, A_wo, B_x, B_w1, B_b1, B_w2, B_b2, gate_w):
    def _A_ref(x, wqkv, w_phi, wo):
        B, S, D = x.shape
        H = 16; Dh = D // H
        qkv = (lambda x, *d: x.permute(*d))((x @ wqkv).reshape(B, S, 3, H, Dh), 2, 0, 3, 1, 4)
        q, k, v = qkv[0], qkv[1], qkv[2]
        pq = torch.einsum("bhsd,hdf->bhsf", q, w_phi)
        pk = torch.einsum("bhsd,hdf->bhsf", k, w_phi)
        phi_q = torch.concatenate([_softmax(pq, axis=-1), _softmax(-pq, axis=-1)], axis=-1)
        phi_k = torch.concatenate([_softmax(pk, axis=-1), _softmax(-pk, axis=-1)], axis=-1)
        kv = torch.einsum("bhsf,bhsd->bhfd", phi_k, v)
        z  = torch.einsum("bhsf->bhf", phi_k)
        num = torch.einsum("bhqf,bhfd->bhqd", phi_q, kv)
        den = torch.einsum("bhqf,bhf->bhq", phi_q, z)[..., None] + 1e-6
        o = num / den
        return (lambda x, *d: x.permute(*d))(o, 0, 2, 1, 3).reshape(B, S, D) @ wo

    def _B_ref(x, w1, b1, w2, b2):
        h = torch.einsum("bsd,df->bsf", x, w1) + b1
        h = _gelu(h)
        return torch.einsum("bsf,fd->bsd", h, w2) + b2

    x = A_x
    g = _sigmoid((x * gate_w).sum(-1, keepdims=True))
    a = _A_ref(x, A_wqkv, A_w_phi, A_wo)
    b = _B_ref(x, B_w1, B_b1, B_w2, B_b2)
    return g * a + (1 - g) * b
```

```asm
; @launch grid=(256,1,1) block=(512,1,1) lds=163840
.amdgcn_target "amdgcn-amd-amdhsa--gfx950"
.text
.globl gated_mix__linear_kernel_hedgehog__dense_activation_gelu__prompt_kernel
.p2align 8
.type gated_mix__linear_kernel_hedgehog__dense_activation_gelu__prompt_kernel,@function
gated_mix__linear_kernel_hedgehog__dense_activation_gelu__prompt_kernel:
    s_cmp_ge_u32 s2, 256
    s_cbranch_scc1 L_end
    s_load_dwordx16 s[16:31], s[0:1], 0
    s_load_dwordx8 s[32:39], s[0:1], 64
    s_load_dwordx2 s[40:41], s[0:1], 96
    v_lshrrev_b32 v8, 6, v0
    v_and_b32 v1, 63, v0
    v_readfirstlane_b32 s74, v8
    v_lshlrev_b32 v2, 4, v1
    s_and_b32 s90, s2, 7
    s_lshr_b32 s91, s2, 3
    s_lshr_b32 s92, s2, 5
    s_lshl_b32 s92, s92, 3
    s_or_b32 s92, s92, s74
    s_cmp_lg_u32 s92, 7
    s_cbranch_scc1 L_nopf
    s_getpc_b64 s[92:93]
L_pc:
    s_lshl_b32 s94, s91, 7
    s_sub_u32 s92, s92, L_pc - gated_mix__linear_kernel_hedgehog__dense_activation_gelu__prompt_kernel
    s_subb_u32 s93, s93, 0
    s_add_u32 s92, s92, s94
    s_addc_u32 s93, s93, 0
    v_lshlrev_b32 v8, 9, v1
    s_mov_b32 exec_hi, 0xffffff
    global_load_dword v5, v8, s[92:93]
    s_mov_b32 exec_hi, -1
L_nopf:
    s_and_b32 s92, s90, 2
    s_lshl_b32 s92, s92, 1
    s_and_b32 s93, s90, 1
    s_cmp_lt_u32 s91, 4
    s_cselect_b32 s94, 14, 12
    s_add_u32 s93, s93, s94
    s_lshr_b32 s94, s91, 3
    s_lshl_b32 s73, s94, 2
    s_and_b32 s72, s90, 3
    s_add_u32 s73, s73, s72
    s_sub_u32 s73, s73, 4
    s_cmp_lt_u32 s91, 8
    s_cselect_b32 s73, s93, s73
    s_cselect_b32 s92, s92, 0
    s_and_b32 s93, s91, 7
    s_xor_b32 s93, s93, s92
    s_and_b32 s72, s90, 4
    s_lshl_b32 s72, s72, 1
    s_add_u32 s72, s72, s93
    s_and_b32 s75, s74, 3
    s_lshl_b32 s89, s73, 8
    s_cmp_ge_u32 s74, 4
    s_cbranch_scc1 L_M
    s_setprio 1
    s_lshl_b32 s94, s94, 1
    s_add_u32 s92, s93, s94
    s_cmp_ge_u32 s92, 7
    s_cselect_b32 s93, 7, 0
    s_sub_u32 s77, s92, s93
    s_and_b32 s92, s2, 3
    s_mul_i32 s92, s92, 2
    s_bfe_u32 s93, s2, 0x10002
    s_mul_i32 s93, s93, 4
    s_add_u32 s92, s92, s93
    s_and_b32 s93, s72, 1
    s_mul_i32 s93, s93, 2
    s_add_u32 s92, s92, s93
    s_bfe_u32 s93, s72, 0x10001
    s_mul_i32 s93, s93, 1
    s_add_u32 s92, s92, s93
    s_bfe_u32 s93, s2, 0x10006
    s_mul_i32 s93, s93, 1
    s_add_u32 s92, s92, s93
    s_mul_i32 s93, s92, 37
    s_lshr_b32 s93, s93, 8
    s_mul_i32 s93, s93, 7
    s_sub_u32 s77, s92, s93
    s_lshl_b32 s80, s77, 12
    s_add_u32 s77, s77, 1
    s_cmp_eq_u32 s77, 7
    s_cselect_b32 s77, 0, s77
    s_lshl_b32 s81, s77, 12
    s_add_u32 s77, s77, 1
    s_cmp_eq_u32 s77, 7
    s_cselect_b32 s77, 0, s77
    s_lshl_b32 s87, s75, 12
    s_mul_i32 s88, s72, 114688
    v_lshrrev_b32 v8, 3, v1
    v_and_b32 v9, 7, v1
    v_lshrrev_b32 v10, 1, v8
    v_xor_b32 v10, v9, v10
    s_lshl_b32 s92, s75, 5
    v_add_u32 v11, s92, v8
    v_mul_u32_u24 v11, 896, v11
    v_lshl_add_u32 v64, v10, 4, v11
    v_xor_b32 v10, 4, v10
    v_lshl_add_u32 v65, v10, 4, v11
    v_add_u32 v65, 6144, v65
    v_add_u32 v66, 12288, v64
    v_add_u32 v67, 12288, v65
    v_lshrrev_b32 v8, 4, v1
    v_and_b32 v9, 15, v1
    v_lshlrev_b32 v10, 2, v8
    v_xor_b32 v10, v9, v10
    s_lshl_b32 s92, s75, 4
    v_add_u32 v11, s92, v8
    v_mul_u32_u24 v11, 3584, v11
    v_lshl_add_u32 v68, v10, 4, v11
    v_xor_b32 v10, 2, v10
    v_lshl_add_u32 v11, v10, 4, v11
    v_add_u32 v69, 13312, v68
    v_add_u32 v70, 26624, v11
    v_add_u32 v71, 39936, v11
    s_waitcnt lgkmcnt(0)
    s_mov_b32 s44, s16
    s_and_b32 s45, s17, 0xffff
    s_mov_b32 s46, 1835008
    s_mov_b32 s47, 0x20000
    s_mov_b32 s48, s26
    s_and_b32 s49, s27, 0xffff
    s_mov_b32 s50, 1605632
    s_mov_b32 s51, 0x20000
    s_cmp_ge_u32 s73, 14
    s_cbranch_scc1 L_a1
    s_lshr_b32 s95, s80, 5
    s_add_u32 s95, s95, s88
    s_add_u32 m0, s87, 0
    s_nop 0
    buffer_load_dwordx4 v64, s[44:47], s95 offen offset:0 lds
    buffer_load_dwordx4 v65, s[44:47], s95 offen offset:1024 lds
    buffer_load_dwordx4 v66, s[44:47], s95 offen offset:2048 lds
    buffer_load_dwordx4 v67, s[44:47], s95 offen offset:3072 lds
    s_mul_i32 s95, s80, 56
    s_add_u32 s95, s95, s89
    s_add_u32 m0, s87, 16384
    s_nop 0
    buffer_load_dwordx4 v68, s[48:51], s95 offen offset:0 lds
    buffer_load_dwordx4 v69, s[48:51], s95 offen offset:1024 lds
    buffer_load_dwordx4 v70, s[48:51], s95 offen offset:2048 lds
    buffer_load_dwordx4 v71, s[48:51], s95 offen offset:3072 lds
    s_lshr_b32 s95, s81, 5
    s_add_u32 s95, s95, s88
    s_add_u32 m0, s87, 32768
    s_nop 0
    buffer_load_dwordx4 v64, s[44:47], s95 offen offset:0 lds
    buffer_load_dwordx4 v65, s[44:47], s95 offen offset:1024 lds
    buffer_load_dwordx4 v66, s[44:47], s95 offen offset:2048 lds
    buffer_load_dwordx4 v67, s[44:47], s95 offen offset:3072 lds
    s_mul_i32 s95, s81, 56
    s_add_u32 s95, s95, s89
    s_add_u32 m0, s87, 49152
    s_nop 0
    buffer_load_dwordx4 v68, s[48:51], s95 offen offset:0 lds
    buffer_load_dwordx4 v69, s[48:51], s95 offen offset:1024 lds
L_a1:
    s_load_dword s42, s[40:41], 0
    s_lshl_b32 s82, s77, 12
    s_add_u32 s77, s77, 1
    s_cmp_eq_u32 s77, 7
    s_cselect_b32 s77, 0, s77
    s_lshl_b32 s83, s77, 12
    s_add_u32 s77, s77, 1
    s_cmp_eq_u32 s77, 7
    s_cselect_b32 s77, 0, s77
    s_lshl_b32 s84, s77, 12
    s_add_u32 s77, s77, 1
    s_cmp_eq_u32 s77, 7
    s_cselect_b32 s77, 0, s77
    s_lshl_b32 s85, s77, 12
    s_add_u32 s77, s77, 1
    s_cmp_eq_u32 s77, 7
    s_cselect_b32 s77, 0, s77
    s_lshl_b32 s86, s77, 12
    s_mov_b32 s60, s40
    s_and_b32 s61, s41, 0xffff
    s_mov_b32 s62, 14680064
    s_mov_b32 s63, 0x20000
    s_mov_b32 s64, s36
    s_and_b32 s65, s37, 0xffff
    s_mov_b32 s66, 1835008
    s_mov_b32 s67, 0x20000
    s_mov_b32 s52, s30
    s_and_b32 s53, s31, 0xffff
    s_mov_b32 s54, 1605632
    s_mov_b32 s55, 0x20000
    s_and_b32 s90, s2, 7
    s_lshr_b32 s91, s2, 3
    s_mul_i32 s92, s91, 37
    s_lshr_b32 s92, s92, 8
    s_mul_i32 s93, s92, 7
    s_sub_u32 s43, s91, s93
    s_lshl_b32 s92, s92, 1
    s_lshl_b32 s93, s90, 3
    s_add_u32 s3, s92, s93
    s_cmp_lt_u32 s91, 28
    s_cselect_b32 s101, 1, 0
    s_and_b32 s92, s75, 1
    s_mul_i32 s93, s75, 7
    s_add_u32 s94, s93, s92
    s_cmp_eq_u32 s92, 0
    s_cselect_b32 s92, 6, 0
    s_add_u32 s92, s92, s93
    s_lshl_b32 s90, s43, 7
    s_mul_i32 s10, s94, 57344
    s_add_u32 s10, s10, s90
    s_mul_i32 s13, s92, 57344
    s_add_u32 s13, s13, s90
    s_lshl_b32 s14, s75, 13
    v_lshrrev_b32 v8, 3, v1
    v_and_b32 v9, 7, v1
    v_bfe_u32 v10, v1, 4, 1
    v_lshlrev_b32 v10, 2, v10
    v_xor_b32 v9, v9, v10
    v_mul_u32_u24 v8, 896, v8
    v_lshl_add_u32 v18, v9, 4, v8
    v_add_u32 v19, 6144, v18
    v_add_u32 v20, 12288, v18
    v_add_u32 v21, 18432, v18
    v_mov_b32 v6, 157696
    s_mov_b32 s98, 0
    s_mov_b32 s99, -1
    s_mov_b32 s24, 0x10000000
    s_mov_b32 s25, 0x10000000
    v_and_b32 v8, 31, v1
    v_lshrrev_b32 v10, 5, v1
    v_bfe_u32 v11, v1, 1, 3
    v_xor_b32 v11, v10, v11
    s_lshl_b32 s90, s75, 12
    v_lshlrev_b32 v8, 7, v8
    v_lshl_add_u32 v8, v11, 4, v8
    v_add_u32 v14, s90, v8
    v_xor_b32 v15, 32, v14
    v_xor_b32 v16, 64, v14
    v_xor_b32 v17, 96, v14
    v_bfe_u32 v12, v1, 4, 1
    v_lshlrev_b32 v12, 5, v12
    v_and_b32 v11, 3, v1
    v_lshl_add_u32 v12, v11, 3, v12
    v_bfe_u32 v11, v1, 2, 2
    v_lshrrev_b32 v10, 5, v1
    v_lshl_add_u32 v8, v10, 3, v11
    v_lshl_add_u32 v30, v8, 6, v12
    v_lshl_add_u32 v8, v10, 2, v11
    v_mul_u32_u24 v9, 56, v8
    v_add_u32 v9, v9, v12
    v_add_u32 v25, 155648, v9
    v_lshlrev_b32 v24, 2, v1
    s_lshl_b32 s90, s75, 10
    s_add_u32 s90, s90, 32768
    v_and_b32 v7, 7, v1
    v_lshl_add_u32 v7, v7, 7, s90
    s_mul_i32 s15, s73, 86016
    s_mul_i32 s35, s75, 7168
    s_add_u32 s15, s15, s35
    s_add_u32 s15, s15, 1048576
    s_waitcnt lgkmcnt(0)
    s_add_u32 s78, s42, 0x9E3779B9
    s_mov_b32 s79, s78
    v_mov_b32 v4, s78
    s_cmp_lt_u32 s73, 14
    s_nop 0
    s_cbranch_scc1 L_a2
    s_mul_i32 s90, s75, 3072
    s_add_u32 s90, s90, 98304
    s_barrier
    s_lshr_b32 s95, s80, 5
    s_add_u32 s95, s95, s88
    s_add_u32 m0, s87, 0
    s_nop 0
    buffer_load_dwordx4 v64, s[44:47], s95 offen offset:0 lds
    buffer_load_dwordx4 v65, s[44:47], s95 offen offset:1024 lds
    buffer_load_dwordx4 v66, s[44:47], s95 offen offset:2048 lds
    buffer_load_dwordx4 v67, s[44:47], s95 offen offset:3072 lds
    s_barrier
    s_lshr_b32 s95, s81, 5
    s_add_u32 s95, s95, s88
    s_add_u32 m0, s87, 16384
    s_nop 0
    buffer_load_dwordx4 v64, s[44:47], s95 offen offset:0 lds
    buffer_load_dwordx4 v65, s[44:47], s95 offen offset:1024 lds
    buffer_load_dwordx4 v66, s[44:47], s95 offen offset:2048 lds
    buffer_load_dwordx4 v67, s[44:47], s95 offen offset:3072 lds
    s_lshr_b32 s95, s82, 5
    s_add_u32 s95, s95, s88
    s_add_u32 m0, s87, 32768
    s_nop 0
    buffer_load_dwordx4 v64, s[44:47], s95 offen offset:0 lds
    buffer_load_dwordx4 v65, s[44:47], s95 offen offset:1024 lds
    buffer_load_dwordx4 v66, s[44:47], s95 offen offset:2048 lds
    buffer_load_dwordx4 v67, s[44:47], s95 offen offset:3072 lds
    s_lshr_b32 s95, s83, 5
    s_add_u32 s95, s95, s88
    s_add_u32 m0, s87, 49152
    s_nop 0
    buffer_load_dwordx4 v64, s[44:47], s95 offen offset:0 lds
    buffer_load_dwordx4 v65, s[44:47], s95 offen offset:1024 lds
    buffer_load_dwordx4 v66, s[44:47], s95 offen offset:2048 lds
    buffer_load_dwordx4 v67, s[44:47], s95 offen offset:3072 lds
    s_lshr_b32 s95, s84, 5
    s_add_u32 s95, s95, s88
    s_add_u32 m0, s87, 65536
    s_nop 0
    buffer_load_dwordx4 v64, s[44:47], s95 offen offset:0 lds
    buffer_load_dwordx4 v65, s[44:47], s95 offen offset:1024 lds
    buffer_load_dwordx4 v66, s[44:47], s95 offen offset:2048 lds
    buffer_load_dwordx4 v67, s[44:47], s95 offen offset:3072 lds
    s_lshr_b32 s95, s85, 5
    s_add_u32 s95, s95, s88
    s_add_u32 m0, s87, 81920
    s_nop 0
    buffer_load_dwordx4 v64, s[44:47], s95 offen offset:0 lds
    buffer_load_dwordx4 v65, s[44:47], s95 offen offset:1024 lds
    buffer_load_dwordx4 v66, s[44:47], s95 offen offset:2048 lds
    buffer_load_dwordx4 v67, s[44:47], s95 offen offset:3072 lds
    s_lshr_b32 s95, s86, 5
    s_add_u32 s95, s95, s88
    s_add_u32 m0, s87, s90
    s_nop 0
    buffer_load_dwordx4 v64, s[44:47], s95 offen offset:0 lds
    buffer_load_dwordx4 v65, s[44:47], s95 offen offset:1024 lds
    buffer_load_dwordx4 v66, s[44:47], s95 offen offset:2048 lds
    buffer_load_dwordx4 v67, s[44:47], s95 offen offset:3072 lds
    s_waitcnt vmcnt(0)
    ds_read_b128 v[144:147], v14 offset:0
    ds_read_b128 v[148:151], v15 offset:0
    ds_read_b128 v[152:155], v16 offset:0
    ds_read_b128 v[156:159], v17 offset:0
    ds_read_b128 v[160:163], v14 offset:16384
    ds_read_b128 v[164:167], v15 offset:16384
    ds_read_b128 v[168:171], v16 offset:16384
    ds_read_b128 v[172:175], v17 offset:16384
    s_waitcnt lgkmcnt(4)
    ds_read_b128 v[176:179], v14 offset:32768
    ds_read_b128 v[180:183], v15 offset:32768
    ds_read_b128 v[184:187], v16 offset:32768
    ds_read_b128 v[188:191], v17 offset:32768
    ds_read_b128 v[192:195], v14 offset:49152
    ds_read_b128 v[196:199], v15 offset:49152
    ds_read_b128 v[200:203], v16 offset:49152
    ds_read_b128 v[204:207], v17 offset:49152
    s_waitcnt lgkmcnt(4)
    v_add_u32 v14, 65536, v14
    v_add_u32 v15, 65536, v15
    v_add_u32 v16, 65536, v16
    v_add_u32 v17, 65536, v17
    ds_read_b128 v[208:211], v14 offset:0
    ds_read_b128 v[212:215], v15 offset:0
    ds_read_b128 v[216:219], v16 offset:0
    ds_read_b128 v[220:223], v17 offset:0
    ds_read_b128 v[224:227], v14 offset:16384
    ds_read_b128 v[228:231], v15 offset:16384
    ds_read_b128 v[232:235], v16 offset:16384
    ds_read_b128 v[236:239], v17 offset:16384
    s_waitcnt lgkmcnt(4)
    s_sub_u32 s90, s90, 65536
    v_add_u32 v14, s90, v14
    v_add_u32 v15, s90, v15
    v_add_u32 v16, s90, v16
    v_add_u32 v17, s90, v17
    ds_read_b128 v[240:243], v14 offset:0
    ds_read_b128 v[244:247], v15 offset:0
    ds_read_b128 v[248:251], v16 offset:0
    ds_read_b128 v[252:255], v17 offset:0
    s_waitcnt lgkmcnt(0)
    buffer_load_dword v5, v7, s[60:63], 0 offen sc1
    s_branch L_a3
L_a2:
    s_waitcnt vmcnt(6)
    s_barrier
    ds_read_b128 v[144:147], v14 offset:0
    ds_read_b128 v[148:151], v15 offset:0
    ds_read_b128 v[152:155], v16 offset:0
    ds_read_b128 v[156:159], v17 offset:0
    buffer_load_dwordx4 v70, s[48:51], s95 offen offset:2048 lds
    buffer_load_dwordx4 v71, s[48:51], s95 offen offset:3072 lds
    s_lshr_b32 s95, s82, 5
    s_add_u32 s95, s95, s88
    s_add_u32 m0, s87, 65536
    s_nop 0
    buffer_load_dwordx4 v64, s[44:47], s95 offen offset:0 lds
    buffer_load_dwordx4 v65, s[44:47], s95 offen offset:1024 lds
    buffer_load_dwordx4 v66, s[44:47], s95 offen offset:2048 lds
    buffer_load_dwordx4 v67, s[44:47], s95 offen offset:3072 lds
    s_mul_i32 s95, s82, 56
    s_add_u32 s95, s95, s89
    s_add_u32 m0, s87, 81920
    s_nop 0
    buffer_load_dwordx4 v68, s[48:51], s95 offen offset:0 lds
    buffer_load_dwordx4 v69, s[48:51], s95 offen offset:1024 lds
    buffer_load_dwordx4 v70, s[48:51], s95 offen offset:2048 lds
    buffer_load_dwordx4 v71, s[48:51], s95 offen offset:3072 lds
    s_lshr_b32 s95, s83, 5
    s_add_u32 s95, s95, s88
    s_add_u32 m0, s87, 98304
    s_nop 0
    buffer_load_dwordx4 v64, s[44:47], s95 offen offset:0 lds
    s_waitcnt vmcnt(9)
    s_barrier
    ds_read_b128 v[160:163], v14 offset:32768
    ds_read_b128 v[164:167], v15 offset:32768
    ds_read_b128 v[168:171], v16 offset:32768
    ds_read_b128 v[172:175], v17 offset:32768
    buffer_load_dwordx4 v65, s[44:47], s95 offen offset:1024 lds
    buffer_load_dwordx4 v66, s[44:47], s95 offen offset:2048 lds
    buffer_load_dwordx4 v67, s[44:47], s95 offen offset:3072 lds
    s_mul_i32 s95, s83, 56
    s_add_u32 s95, s95, s89
    s_add_u32 m0, s87, 114688
    s_nop 0
    buffer_load_dwordx4 v68, s[48:51], s95 offen offset:0 lds
    buffer_load_dwordx4 v69, s[48:51], s95 offen offset:1024 lds
    buffer_load_dwordx4 v70, s[48:51], s95 offen offset:2048 lds
    buffer_load_dwordx4 v71, s[48:51], s95 offen offset:3072 lds
    v_add_u32 v14, 65536, v14
    v_add_u32 v15, 65536, v15
    v_add_u32 v16, 65536, v16
    v_add_u32 v17, 65536, v17
    s_waitcnt vmcnt(8)
    s_waitcnt lgkmcnt(4)
    s_barrier
    ds_read_b128 v[176:179], v14 offset:0
    ds_read_b128 v[180:183], v15 offset:0
    ds_read_b128 v[184:187], v16 offset:0
    ds_read_b128 v[188:191], v17 offset:0
    s_lshr_b32 s95, s84, 5
    s_add_u32 s95, s95, s88
    s_add_u32 m0, s87, 0
    s_nop 0
    buffer_load_dwordx4 v64, s[44:47], s95 offen offset:0 lds
    buffer_load_dwordx4 v65, s[44:47], s95 offen offset:1024 lds
    buffer_load_dwordx4 v66, s[44:47], s95 offen offset:2048 lds
    buffer_load_dwordx4 v67, s[44:47], s95 offen offset:3072 lds
    s_mul_i32 s95, s84, 56
    s_add_u32 s95, s95, s89
    s_add_u32 m0, s87, 16384
    s_nop 0
    buffer_load_dwordx4 v68, s[48:51], s95 offen offset:0 lds
    buffer_load_dwordx4 v69, s[48:51], s95 offen offset:1024 lds
    buffer_load_dwordx4 v70, s[48:51], s95 offen offset:2048 lds
    buffer_load_dwordx4 v71, s[48:51], s95 offen offset:3072 lds
    s_waitcnt vmcnt(8)
    s_waitcnt lgkmcnt(4)
    s_barrier
    ds_read_b128 v[192:195], v14 offset:32768
    ds_read_b128 v[196:199], v15 offset:32768
    ds_read_b128 v[200:203], v16 offset:32768
    ds_read_b128 v[204:207], v17 offset:32768
    s_lshr_b32 s95, s85, 5
    s_add_u32 s95, s95, s88
    s_add_u32 m0, s87, 32768
    s_nop 0
    buffer_load_dwordx4 v64, s[44:47], s95 offen offset:0 lds
    buffer_load_dwordx4 v65, s[44:47], s95 offen offset:1024 lds
    buffer_load_dwordx4 v66, s[44:47], s95 offen offset:2048 lds
    buffer_load_dwordx4 v67, s[44:47], s95 offen offset:3072 lds
    s_mul_i32 s95, s85, 56
    s_add_u32 s95, s95, s89
    s_add_u32 m0, s87, 49152
    s_nop 0
    buffer_load_dwordx4 v68, s[48:51], s95 offen offset:0 lds
    buffer_load_dwordx4 v69, s[48:51], s95 offen offset:1024 lds
    buffer_load_dwordx4 v70, s[48:51], s95 offen offset:2048 lds
    buffer_load_dwordx4 v71, s[48:51], s95 offen offset:3072 lds
    v_subrev_u32 v14, 65536, v14
    v_subrev_u32 v15, 65536, v15
    v_subrev_u32 v16, 65536, v16
    v_subrev_u32 v17, 65536, v17
    s_waitcnt vmcnt(8)
    s_waitcnt lgkmcnt(4)
    s_barrier
    ds_read_b128 v[208:211], v14 offset:0
    ds_read_b128 v[212:215], v15 offset:0
    ds_read_b128 v[216:219], v16 offset:0
    ds_read_b128 v[220:223], v17 offset:0
    s_lshr_b32 s95, s86, 5
    s_add_u32 s95, s95, s88
    s_add_u32 m0, s87, 65536
    s_nop 0
    buffer_load_dwordx4 v64, s[44:47], s95 offen offset:0 lds
    buffer_load_dwordx4 v65, s[44:47], s95 offen offset:1024 lds
    buffer_load_dwordx4 v66, s[44:47], s95 offen offset:2048 lds
    buffer_load_dwordx4 v67, s[44:47], s95 offen offset:3072 lds
    s_mul_i32 s95, s86, 56
    s_add_u32 s95, s95, s89
    s_add_u32 m0, s87, 81920
    s_nop 0
    buffer_load_dwordx4 v68, s[48:51], s95 offen offset:0 lds
    buffer_load_dwordx4 v69, s[48:51], s95 offen offset:1024 lds
    buffer_load_dwordx4 v70, s[48:51], s95 offen offset:2048 lds
    buffer_load_dwordx4 v71, s[48:51], s95 offen offset:3072 lds
    buffer_load_dword v5, v7, s[60:63], 0 offen sc1
    s_waitcnt vmcnt(9)
    s_waitcnt lgkmcnt(4)
    s_barrier
    ds_read_b128 v[224:227], v14 offset:32768
    ds_read_b128 v[228:231], v15 offset:32768
    ds_read_b128 v[232:235], v16 offset:32768
    ds_read_b128 v[236:239], v17 offset:32768
    v_add_u32 v14, 65536, v14
    v_add_u32 v15, 65536, v15
    v_add_u32 v16, 65536, v16
    v_add_u32 v17, 65536, v17
    s_waitcnt vmcnt(1)
    v_mov_b32 v13, 1
    s_mov_b64 exec, 1
    ds_add_u32 v6, v13 offset:36
    s_mov_b64 exec, -1
    ds_read_b128 v[240:243], v14 offset:0
    ds_read_b128 v[244:247], v15 offset:0
    ds_read_b128 v[248:251], v16 offset:0
    ds_read_b128 v[252:255], v17 offset:0
L_a3:
    v_mov_b32 v13, 1
    s_mov_b64 exec, 1
    ds_add_u32 v6, v13 offset:0
    s_mov_b64 exec, -1
    s_mov_b32 s100, 20000
    s_waitcnt vmcnt(0)
L_poll1:
    v_cmp_ne_u32 vcc, s78, v5
    s_nop 4
    s_cbranch_vccz L_polld2
    s_sub_u32 s100, s100, 1
    s_cbranch_scc1 L_polld2
    s_sleep 10
    buffer_load_dword v5, v7, s[60:63], 0 offen sc1
    s_waitcnt vmcnt(0)
    s_branch L_poll1
L_polld2:
    s_add_u32 s95, s15, 28672
    s_add_u32 m0, s35, 98304
    s_nop 0
    buffer_load_dwordx4 v2, s[60:63], s95 offen offset:0 sc1 lds
    buffer_load_dwordx4 v2, s[60:63], s95 offen offset:1024 sc1 lds
    buffer_load_dwordx4 v2, s[60:63], s95 offen offset:2048 sc1 lds
    buffer_load_dwordx4 v2, s[60:63], s95 offen offset:3072 sc1 lds
    s_add_u32 s95, s15, 32768
    s_add_u32 m0, s35, 102400
    s_nop 0
    buffer_load_dwordx4 v2, s[60:63], s95 offen offset:0 sc1 lds
    buffer_load_dwordx4 v2, s[60:63], s95 offen offset:1024 sc1 lds
    buffer_load_dwordx4 v2, s[60:63], s95 offen offset:2048 sc1 lds
    s_add_u32 s95, s15, 57344
    s_add_u32 m0, s35, 126976
    s_nop 0
    buffer_load_dwordx4 v2, s[60:63], s95 offen offset:0 sc1 lds
    buffer_load_dwordx4 v2, s[60:63], s95 offen offset:1024 sc1 lds
    buffer_load_dwordx4 v2, s[60:63], s95 offen offset:2048 sc1 lds
    buffer_load_dwordx4 v2, s[60:63], s95 offen offset:3072 sc1 lds
    s_add_u32 s95, s15, 61440
    s_add_u32 m0, s35, 131072
    s_nop 0
    buffer_load_dwordx4 v2, s[60:63], s95 offen offset:0 sc1 lds
    buffer_load_dwordx4 v2, s[60:63], s95 offen offset:1024 sc1 lds
    buffer_load_dwordx4 v2, s[60:63], s95 offen offset:2048 sc1 lds
    v_add_u32 v7, 4096, v7
    buffer_load_dword v5, v7, s[60:63], 0 offen sc1
    s_mov_b32 s4, 0x3fb8aa3b
    s_mov_b32 s5, 0x3fb8aa3b
    ds_read_b64_tr_b16 v[56:57], v25 offset:0
    ds_read_b64_tr_b16 v[58:59], v25 offset:448
    ds_read_b64_tr_b16 v[60:61], v25 offset:896
    ds_read_b64_tr_b16 v[62:63], v25 offset:1344
    s_lshl_b32 s90, s75, 11
    s_lshl_b32 s91, s73, 13
    s_add_u32 s9, s91, s90
    s_add_u32 s8, s9, 3538944
    s_lshl_b32 s34, s72, 7
    s_add_u32 s34, s34, s8
    s_add_u32 s9, s9, 2621440
    s_lshl_b32 s90, s72, 2
    s_add_u32 s90, s90, s75
    s_lshr_b32 s91, s90, 1
    s_lshl_b32 s91, s91, 2
    s_lshr_b32 s92, s73, 2
    s_add_u32 s91, s91, s92
    s_lshl_b32 s91, s91, 10
    s_add_u32 s76, s91, 3407872
    s_lshl_b32 s90, s90, 4
    s_add_u32 s90, s90, s73
    s_lshl_b32 s11, s90, 11
    s_add_u32 s11, s11, 4718592
    s_lshl_b32 s92, s90, 7
    s_add_u32 s88, s92, 655232
    v_and_b32 v8, 31, v1
    v_lshrrev_b32 v9, 5, v1
    v_lshlrev_b32 v9, 2, v9
    v_sub_u32 v8, v8, v9
    v_and_b32 v9, 1, v1
    v_lshlrev_b32 v9, 4, v9
    v_mov_b32 v10, 0x3f80
    v_lshlrev_b32 v9, v9, v10
    v_and_b32 v8, -2, v8
    v_cmp_eq_u32 s[90:91], 0, v8
    v_cmp_eq_u32 s[92:93], 2, v8
    v_cmp_eq_u32 s[94:95], 8, v8
    v_cmp_eq_u32 s[96:97], 10, v8
    v_cndmask_b32 v26, 0, v9, s[90:91]
    v_cndmask_b32 v27, 0, v9, s[92:93]
    v_cndmask_b32 v28, 0, v9, s[94:95]
    v_cndmask_b32 v29, 0, v9, s[96:97]
    v_cmp_eq_u32 s[90:91], 16, v8
    v_cmp_eq_u32 s[92:93], 18, v8
    v_cmp_eq_u32 s[94:95], 24, v8
    v_cmp_eq_u32 s[96:97], 26, v8
    v_cndmask_b32 v128, 0, v9, s[90:91]
    v_cndmask_b32 v129, 0, v9, s[92:93]
    v_cndmask_b32 v130, 0, v9, s[94:95]
    v_cndmask_b32 v131, 0, v9, s[96:97]
    s_cmp_eq_u32 s101, 1
    s_cselect_b32 s54, s54, 0
    s_waitcnt vmcnt(8)
    v_mov_b32 v13, 1
    s_mov_b64 exec, 1
    ds_add_u32 v6, v13 offset:4
    s_mov_b64 exec, -1
    s_mov_b32 s100, 160000
L_aw3:
    ds_read_b32 v13, v6 offset:4
    s_waitcnt lgkmcnt(0)
    v_cmp_ne_u32 vcc, 4, v13
    s_nop 4
    s_cbranch_vccz L_awd4
    s_sleep 1
    s_sub_u32 s100, s100, 1
    s_cbranch_scc0 L_aw3
L_awd4:
    v_cndmask_b32 v62, v62, 0, s[98:99]
    v_cndmask_b32 v63, v63, 0, s[98:99]
    v_add_u32 v14, 98304, v30
    v_add_u32 v22, s80, v14
    ds_read_b64_tr_b16 v[32:33], v22 offset:0
    ds_read_b64_tr_b16 v[34:35], v22 offset:256
    ds_read_b64_tr_b16 v[36:37], v22 offset:1024
    ds_read_b64_tr_b16 v[38:39], v22 offset:1280
    ds_read_b64_tr_b16 v[40:41], v22 offset:2048
    ds_read_b64_tr_b16 v[42:43], v22 offset:2304
    ds_read_b64_tr_b16 v[44:45], v22 offset:3072
    ds_read_b64_tr_b16 v[46:47], v22 offset:3328
    v_add_u32 v22, s81, v14
    ds_read_b64_tr_b16 v[48:49], v22 offset:0
    ds_read_b64_tr_b16 v[50:51], v22 offset:256
    ds_read_b64_tr_b16 v[52:53], v22 offset:1024
    ds_read_b64_tr_b16 v[54:55], v22 offset:1280
    s_waitcnt lgkmcnt(10)
    v_mfma_f32_32x32x16_bf16 v[96:111], v[32:35], v[144:147], 0
    ds_read_b64_tr_b16 v[32:33], v22 offset:2048
    ds_read_b64_tr_b16 v[34:35], v22 offset:2304
    s_waitcnt lgkmcnt(10)
    v_mfma_f32_32x32x16_bf16 v[96:111], v[36:39], v[148:151], v[96:111]
    ds_read_b64_tr_b16 v[36:37], v22 offset:3072
    ds_read_b64_tr_b16 v[38:39], v22 offset:3328
    s_waitcnt lgkmcnt(10)
    v_mfma_f32_32x32x16_bf16 v[96:111], v[40:43], v[152:155], v[96:111]
    v_add_u32 v22, s82, v14
    ds_read_b64_tr_b16 v[40:41], v22 offset:0
    ds_read_b64_tr_b16 v[42:43], v22 offset:256
    s_waitcnt lgkmcnt(10)
    v_mfma_f32_32x32x16_bf16 v[96:111], v[44:47], v[156:159], v[96:111]
    ds_read_b64_tr_b16 v[44:45], v22 offset:1024
    ds_read_b64_tr_b16 v[46:47], v22 offset:1280
    s_waitcnt lgkmcnt(10)
    v_mfma_f32_32x32x16_bf16 v[96:111], v[48:51], v[160:163], v[96:111]
    ds_read_b64_tr_b16 v[48:49], v22 offset:2048
    ds_read_b64_tr_b16 v[50:51], v22 offset:2304
    s_waitcnt lgkmcnt(10)
    v_mfma_f32_32x32x16_bf16 v[96:111], v[52:55], v[164:167], v[96:111]
    ds_read_b64_tr_b16 v[52:53], v22 offset:3072
    ds_read_b64_tr_b16 v[54:55], v22 offset:3328
    s_waitcnt lgkmcnt(10)
    v_mfma_f32_32x32x16_bf16 v[96:111], v[32:35], v[168:171], v[96:111]
    v_add_u32 v22, s83, v14
    ds_read_b64_tr_b16 v[32:33], v22 offset:0
    ds_read_b64_tr_b16 v[34:35], v22 offset:256
    s_waitcnt lgkmcnt(10)
    v_mfma_f32_32x32x16_bf16 v[96:111], v[36:39], v[172:175], v[96:111]
    ds_read_b64_tr_b16 v[36:37], v22 offset:1024
    ds_read_b64_tr_b16 v[38:39], v22 offset:1280
    s_waitcnt lgkmcnt(10)
    v_mfma_f32_32x32x16_bf16 v[96:111], v[40:43], v[176:179], v[96:111]
    ds_read_b64_tr_b16 v[40:41], v22 offset:2048
    ds_read_b64_tr_b16 v[42:43], v22 offset:2304
    s_waitcnt lgkmcnt(10)
    v_mfma_f32_32x32x16_bf16 v[96:111], v[44:47], v[180:183], v[96:111]
    ds_read_b64_tr_b16 v[44:45], v22 offset:3072
    ds_read_b64_tr_b16 v[46:47], v22 offset:3328
    s_waitcnt lgkmcnt(10)
    v_mfma_f32_32x32x16_bf16 v[96:111], v[48:51], v[184:187], v[96:111]
    v_add_u32 v22, s84, v14
    ds_read_b64_tr_b16 v[48:49], v22 offset:0
    ds_read_b64_tr_b16 v[50:51], v22 offset:256
    s_waitcnt lgkmcnt(10)
    v_mfma_f32_32x32x16_bf16 v[96:111], v[52:55], v[188:191], v[96:111]
    ds_read_b64_tr_b16 v[52:53], v22 offset:1024
    ds_read_b64_tr_b16 v[54:55], v22 offset:1280
    s_mov_b32 s100, 20000
    s_waitcnt vmcnt(0)
    s_nop 7
L_poll5:
    v_cmp_ne_u32 vcc, s78, v5
    s_nop 4
    s_cbranch_vccz L_polld6
    s_sub_u32 s100, s100, 1
    s_cbranch_scc1 L_polld6
    s_sleep 10
    buffer_load_dword v5, v7, s[60:63], 0 offen sc1
    s_waitcnt vmcnt(0)
    s_branch L_poll5
L_polld6:
    v_mov_b32 v13, 1
    s_mov_b64 exec, 1
    ds_add_u32 v6, v13 offset:44
    s_mov_b64 exec, -1
    s_mov_b32 s100, 160000
L_aw7:
    ds_read_b32 v13, v6 offset:0
    s_waitcnt lgkmcnt(0)
    v_cmp_ne_u32 vcc, 8, v13
    s_nop 4
    s_cbranch_vccz L_awd8
    s_sub_u32 s100, s100, 1
    s_cbranch_scc0 L_aw7
L_awd8:
    s_waitcnt lgkmcnt(12)
    v_mfma_f32_32x32x16_bf16 v[96:111], v[32:35], v[192:195], v[96:111]
    ds_read_b64_tr_b16 v[32:33], v22 offset:2048
    ds_read_b64_tr_b16 v[34:35], v22 offset:2304
    s_add_u32 s95, s10, 0
    s_add_u32 m0, s14, 0
    s_nop 0
    buffer_load_dwordx4 v18, s[52:55], s95 offen offset:0 lds
    s_waitcnt lgkmcnt(12)
    v_mfma_f32_32x32x16_bf16 v[96:111], v[36:39], v[196:199], v[96:111]
    ds_read_b64_tr_b16 v[36:37], v22 offset:3072
    ds_read_b64_tr_b16 v[38:39], v22 offset:3328
    s_waitcnt lgkmcnt(12)
    v_mfma_f32_32x32x16_bf16 v[96:111], v[40:43], v[200:203], v[96:111]
    v_add_u32 v22, s85, v14
    ds_read_b64_tr_b16 v[40:41], v22 offset:0
    ds_read_b64_tr_b16 v[42:43], v22 offset:256
    buffer_load_dwordx4 v19, s[52:55], s95 offen offset:1024 lds
    s_waitcnt lgkmcnt(12)
    v_mfma_f32_32x32x16_bf16 v[96:111], v[44:47], v[204:207], v[96:111]
    ds_read_b64_tr_b16 v[44:45], v22 offset:1024
    ds_read_b64_tr_b16 v[46:47], v22 offset:1280
    s_waitcnt lgkmcnt(12)
    v_mfma_f32_32x32x16_bf16 v[96:111], v[48:51], v[208:211], v[96:111]
    ds_read_b64_tr_b16 v[48:49], v22 offset:2048
    ds_read_b64_tr_b16 v[50:51], v22 offset:2304
    buffer_load_dwordx4 v20, s[52:55], s95 offen offset:2048 lds
    s_waitcnt lgkmcnt(12)
    v_mfma_f32_32x32x16_bf16 v[96:111], v[52:55], v[212:215], v[96:111]
    ds_read_b64_tr_b16 v[52:53], v22 offset:3072
    ds_read_b64_tr_b16 v[54:55], v22 offset:3328
    s_waitcnt lgkmcnt(10)
    v_mfma_f32_32x32x16_bf16 v[96:111], v[32:35], v[216:219], v[96:111]
    v_add_u32 v22, s86, v14
    ds_read_b64_tr_b16 v[32:33], v22 offset:0
    ds_read_b64_tr_b16 v[34:35], v22 offset:256
    buffer_load_dwordx4 v21, s[52:55], s95 offen offset:3072 lds
    s_waitcnt lgkmcnt(10)
    v_mfma_f32_32x32x16_bf16 v[96:111], v[36:39], v[220:223], v[96:111]
    ds_read_b64_tr_b16 v[36:37], v22 offset:1024
    ds_read_b64_tr_b16 v[38:39], v22 offset:1280
    s_waitcnt lgkmcnt(10)
    v_mfma_f32_32x32x16_bf16 v[96:111], v[40:43], v[224:227], v[96:111]
    ds_read_b64_tr_b16 v[40:41], v22 offset:2048
    ds_read_b64_tr_b16 v[42:43], v22 offset:2304
    s_add_u32 s95, s10, 28672
    s_add_u32 m0, s14, 4096
    s_nop 0
    buffer_load_dwordx4 v18, s[52:55], s95 offen offset:0 lds
    s_waitcnt lgkmcnt(10)
    v_mfma_f32_32x32x16_bf16 v[96:111], v[44:47], v[228:231], v[96:111]
    ds_read_b64_tr_b16 v[44:45], v22 offset:3072
    ds_read_b64_tr_b16 v[46:47], v22 offset:3328
    s_waitcnt lgkmcnt(10)
    v_mfma_f32_32x32x16_bf16 v[96:111], v[48:51], v[232:235], v[96:111]
    buffer_load_dwordx4 v19, s[52:55], s95 offen offset:1024 lds
    s_waitcnt lgkmcnt(8)
    v_mfma_f32_32x32x16_bf16 v[96:111], v[52:55], v[236:239], v[96:111]
    s_waitcnt lgkmcnt(6)
    v_mfma_f32_32x32x16_bf16 v[96:111], v[32:35], v[240:243], v[96:111]
    buffer_load_dwordx4 v20, s[52:55], s95 offen offset:2048 lds
    s_waitcnt lgkmcnt(4)
    v_mfma_f32_32x32x16_bf16 v[96:111], v[36:39], v[244:247], v[96:111]
    s_waitcnt lgkmcnt(2)
    v_mfma_f32_32x32x16_bf16 v[96:111], v[40:43], v[248:251], v[96:111]
    buffer_load_dwordx4 v21, s[52:55], s95 offen offset:3072 lds
    s_waitcnt lgkmcnt(0)
    v_mfma_f32_32x32x16_bf16 v[96:111], v[44:47], v[252:255], v[96:111]
    s_mov_b32 s100, 160000
    s_nop 10
L_aw9:
    ds_read_b32 v13, v6 offset:44
    s_waitcnt lgkmcnt(0)
    v_cmp_ne_u32 vcc, 4, v13
    s_nop 4
    s_cbranch_vccz L_awd10
    s_sub_u32 s100, s100, 1
    s_cbranch_scc0 L_aw9
L_awd10:
    v_add_u32 v14, 126976, v30
    v_add_u32 v22, s80, v14
    ds_read_b64_tr_b16 v[32:33], v22 offset:0
    ds_read_b64_tr_b16 v[34:35], v22 offset:256
    ds_read_b64_tr_b16 v[36:37], v22 offset:1024
    ds_read_b64_tr_b16 v[38:39], v22 offset:1280
    ds_read_b64_tr_b16 v[40:41], v22 offset:2048
    ds_read_b64_tr_b16 v[42:43], v22 offset:2304
    ds_read_b64_tr_b16 v[44:45], v22 offset:3072
    ds_read_b64_tr_b16 v[46:47], v22 offset:3328
    v_add_u32 v22, s81, v14
    ds_read_b64_tr_b16 v[48:49], v22 offset:0
    ds_read_b64_tr_b16 v[50:51], v22 offset:256
    ds_read_b64_tr_b16 v[52:53], v22 offset:1024
    ds_read_b64_tr_b16 v[54:55], v22 offset:1280
    s_waitcnt lgkmcnt(10)
    v_mfma_f32_32x32x16_bf16 v[112:127], v[144:147], v[32:35], 0
    ds_read_b64_tr_b16 v[32:33], v22 offset:2048
    ds_read_b64_tr_b16 v[34:35], v22 offset:2304
    s_add_u32 s95, s10, 114688
    s_add_u32 m0, s14, 32768
    s_nop 0
    buffer_load_dwordx4 v18, s[52:55], s95 offen offset:0 lds
    s_waitcnt lgkmcnt(10)
    v_mfma_f32_32x32x16_bf16 v[112:127], v[148:151], v[36:39], v[112:127]
    ds_read_b64_tr_b16 v[36:37], v22 offset:3072
    ds_read_b64_tr_b16 v[38:39], v22 offset:3328
    buffer_load_dwordx4 v19, s[52:55], s95 offen offset:1024 lds
    s_waitcnt lgkmcnt(10)
    v_mfma_f32_32x32x16_bf16 v[112:127], v[152:155], v[40:43], v[112:127]
    v_add_u32 v22, s82, v14
    ds_read_b64_tr_b16 v[40:41], v22 offset:0
    ds_read_b64_tr_b16 v[42:43], v22 offset:256
    buffer_load_dwordx4 v20, s[52:55], s95 offen offset:2048 lds
    s_waitcnt lgkmcnt(10)
    v_mfma_f32_32x32x16_bf16 v[112:127], v[156:159], v[44:47], v[112:127]
    ds_read_b64_tr_b16 v[44:45], v22 offset:1024
    ds_read_b64_tr_b16 v[46:47], v22 offset:1280
    s_waitcnt lgkmcnt(10)
    v_mfma_f32_32x32x16_bf16 v[112:127], v[160:163], v[48:51], v[112:127]
    ds_read_b64_tr_b16 v[48:49], v22 offset:2048
    ds_read_b64_tr_b16 v[50:51], v22 offset:2304
    v_cvt_pk_bf16_f32 v64, v96, v97
    v_cvt_pk_bf16_f32 v65, v98, v99
    v_cvt_pk_bf16_f32 v66, v100, v101
    v_cvt_pk_bf16_f32 v67, v102, v103
    v_cvt_pk_bf16_f32 v68, v104, v105
    v_cvt_pk_bf16_f32 v69, v106, v107
    v_cvt_pk_bf16_f32 v70, v108, v109
    v_cvt_pk_bf16_f32 v71, v110, v111
    buffer_load_dwordx4 v21, s[52:55], s95 offen offset:3072 lds
    s_waitcnt lgkmcnt(10)
    v_mfma_f32_32x32x16_bf16 v[112:127], v[164:167], v[52:55], v[112:127]
    ds_read_b64_tr_b16 v[52:53], v22 offset:3072
    ds_read_b64_tr_b16 v[54:55], v22 offset:3328
    s_waitcnt lgkmcnt(10)
    v_mfma_f32_32x32x16_bf16 v[112:127], v[168:171], v[32:35], v[112:127]
    v_add_u32 v22, s83, v14
    ds_read_b64_tr_b16 v[32:33], v22 offset:0
    ds_read_b64_tr_b16 v[34:35], v22 offset:256
    v_mfma_f32_32x32x16_bf16 v[96:111], v[56:59], v[64:67], 0
    v_mfma_f32_32x32x16_bf16 v[96:111], v[60:63], v[68:71], v[96:111]
    s_add_u32 s95, s10, 143360
    s_add_u32 m0, s14, 36864
    s_nop 0
    buffer_load_dwordx4 v18, s[52:55], s95 offen offset:0 lds
    s_waitcnt lgkmcnt(10)
    v_mfma_f32_32x32x16_bf16 v[112:127], v[172:175], v[36:39], v[112:127]
    ds_read_b64_tr_b16 v[36:37], v22 offset:1024
    ds_read_b64_tr_b16 v[38:39], v22 offset:1280
    s_waitcnt lgkmcnt(10)
    v_mfma_f32_32x32x16_bf16 v[112:127], v[176:179], v[40:43], v[112:127]
    ds_read_b64_tr_b16 v[40:41], v22 offset:2048
    ds_read_b64_tr_b16 v[42:43], v22 offset:2304
    buffer_load_dwordx4 v19, s[52:55], s95 offen offset:1024 lds
    s_waitcnt lgkmcnt(10)
    v_mfma_f32_32x32x16_bf16 v[112:127], v[180:183], v[44:47], v[112:127]
    ds_read_b64_tr_b16 v[44:45], v22 offset:3072
    ds_read_b64_tr_b16 v[46:47], v22 offset:3328
    s_waitcnt lgkmcnt(10)
    v_mfma_f32_32x32x16_bf16 v[112:127], v[184:187], v[48:51], v[112:127]
    v_add_u32 v22, s84, v14
    ds_read_b64_tr_b16 v[48:49], v22 offset:0
    ds_read_b64_tr_b16 v[50:51], v22 offset:256
    buffer_load_dwordx4 v20, s[52:55], s95 offen offset:2048 lds
    s_waitcnt lgkmcnt(10)
    v_mfma_f32_32x32x16_bf16 v[112:127], v[188:191], v[52:55], v[112:127]
    ds_read_b64_tr_b16 v[52:53], v22 offset:1024
    ds_read_b64_tr_b16 v[54:55], v22 offset:1280
    s_waitcnt lgkmcnt(10)
    v_mfma_f32_32x32x16_bf16 v[112:127], v[192:195], v[32:35], v[112:127]
    ds_read_b64_tr_b16 v[32:33], v22 offset:2048
    ds_read_b64_tr_b16 v[34:35], v22 offset:2304
    buffer_load_dwordx4 v21, s[52:55], s95 offen offset:3072 lds
    v_cvt_pk_bf16_f32 v97, v96, v97
    v_lshlrev_b32 v96, 16, v97
    v_and_b32 v97, 0xffff0000, v97
    s_waitcnt lgkmcnt(10)
    v_mfma_f32_32x32x16_bf16 v[112:127], v[196:199], v[36:39], v[112:127]
    ds_read_b64_tr_b16 v[36:37], v22 offset:3072
    ds_read_b64_tr_b16 v[38:39], v22 offset:3328
    v_cvt_pk_bf16_f32 v99, v98, v99
    v_lshlrev_b32 v98, 16, v99
    v_and_b32 v99, 0xffff0000, v99
    s_waitcnt lgkmcnt(10)
    v_mfma_f32_32x32x16_bf16 v[112:127], v[200:203], v[40:43], v[112:127]
    v_add_u32 v22, s85, v14
    ds_read_b64_tr_b16 v[40:41], v22 offset:0
    ds_read_b64_tr_b16 v[42:43], v22 offset:256
    s_add_u32 s95, s15, 0
    s_add_u32 m0, s35, 65536
    s_nop 0
    buffer_load_dwordx4 v2, s[60:63], s95 offen offset:0 sc1 lds
    v_cvt_pk_bf16_f32 v101, v100, v101
    v_lshlrev_b32 v100, 16, v101
    v_and_b32 v101, 0xffff0000, v101
    s_waitcnt lgkmcnt(10)
    v_mfma_f32_32x32x16_bf16 v[112:127], v[204:207], v[44:47], v[112:127]
    ds_read_b64_tr_b16 v[44:45], v22 offset:1024
    ds_read_b64_tr_b16 v[46:47], v22 offset:1280
    v_cvt_pk_bf16_f32 v103, v102, v103
    v_lshlrev_b32 v102, 16, v103
    v_and_b32 v103, 0xffff0000, v103
    s_waitcnt lgkmcnt(10)
    v_mfma_f32_32x32x16_bf16 v[112:127], v[208:211], v[48:51], v[112:127]
    ds_read_b64_tr_b16 v[48:49], v22 offset:2048
    ds_read_b64_tr_b16 v[50:51], v22 offset:2304
    buffer_load_dwordx4 v2, s[60:63], s95 offen offset:1024 sc1 lds
    v_cvt_pk_bf16_f32 v105, v104, v105
    v_lshlrev_b32 v104, 16, v105
    v_and_b32 v105, 0xffff0000, v105
    s_waitcnt lgkmcnt(10)
    v_mfma_f32_32x32x16_bf16 v[112:127], v[212:215], v[52:55], v[112:127]
    ds_read_b64_tr_b16 v[52:53], v22 offset:3072
    ds_read_b64_tr_b16 v[54:55], v22 offset:3328
    v_cvt_pk_bf16_f32 v107, v106, v107
    v_lshlrev_b32 v106, 16, v107
    v_and_b32 v107, 0xffff0000, v107
    s_waitcnt lgkmcnt(10)
    v_mfma_f32_32x32x16_bf16 v[112:127], v[216:219], v[32:35], v[112:127]
    v_add_u32 v22, s86, v14
    ds_read_b64_tr_b16 v[32:33], v22 offset:0
    ds_read_b64_tr_b16 v[34:35], v22 offset:256
    buffer_load_dwordx4 v2, s[60:63], s95 offen offset:2048 sc1 lds
    v_cvt_pk_bf16_f32 v109, v108, v109
    v_lshlrev_b32 v108, 16, v109
    v_and_b32 v109, 0xffff0000, v109
    s_waitcnt lgkmcnt(10)
    v_mfma_f32_32x32x16_bf16 v[112:127], v[220:223], v[36:39], v[112:127]
    ds_read_b64_tr_b16 v[36:37], v22 offset:1024
    ds_read_b64_tr_b16 v[38:39], v22 offset:1280
    v_cvt_pk_bf16_f32 v111, v110, v111
    v_lshlrev_b32 v110, 16, v111
    v_and_b32 v111, 0xffff0000, v111
    s_waitcnt lgkmcnt(10)
    v_mfma_f32_32x32x16_bf16 v[112:127], v[224:227], v[40:43], v[112:127]
    ds_read_b64_tr_b16 v[40:41], v22 offset:2048
    ds_read_b64_tr_b16 v[42:43], v22 offset:2304
    buffer_load_dwordx4 v2, s[60:63], s95 offen offset:3072 sc1 lds
    s_waitcnt lgkmcnt(10)
    v_mfma_f32_32x32x16_bf16 v[112:127], v[228:231], v[44:47], v[112:127]
    ds_read_b64_tr_b16 v[44:45], v22 offset:3072
    ds_read_b64_tr_b16 v[46:47], v22 offset:3328
    s_waitcnt lgkmcnt(10)
    v_mfma_f32_32x32x16_bf16 v[112:127], v[232:235], v[48:51], v[112:127]
    s_add_u32 s95, s15, 4096
    s_add_u32 m0, s35, 69632
    s_nop 0
    buffer_load_dwordx4 v2, s[60:63], s95 offen offset:0 sc1 lds
    v_mov_b32 v13, 1
    s_mov_b64 exec, 1
    ds_add_u32 v6, v13 offset:8
    s_mov_b64 exec, -1
    s_waitcnt lgkmcnt(9)
    v_mfma_f32_32x32x16_bf16 v[112:127], v[236:239], v[52:55], v[112:127]
    s_waitcnt lgkmcnt(7)
    v_mfma_f32_32x32x16_bf16 v[112:127], v[240:243], v[32:35], v[112:127]
    buffer_load_dwordx4 v2, s[60:63], s95 offen offset:1024 sc1 lds
    s_waitcnt vmcnt(6)
    v_mov_b32 v13, 1
    s_mov_b64 exec, 1
    ds_add_u32 v6, v13 offset:32
    s_mov_b64 exec, -1
    s_waitcnt lgkmcnt(6)
    v_mfma_f32_32x32x16_bf16 v[112:127], v[244:247], v[36:39], v[112:127]
    s_waitcnt lgkmcnt(4)
    v_mfma_f32_32x32x16_bf16 v[112:127], v[248:251], v[40:43], v[112:127]
    buffer_load_dwordx4 v2, s[60:63], s95 offen offset:2048 sc1 lds
    s_waitcnt lgkmcnt(2)
    v_mfma_f32_32x32x16_bf16 v[112:127], v[252:255], v[44:47], v[112:127]
    v_mov_b32 v40, v128
    v_mov_b32 v41, v129
    v_mov_b32 v42, v130
    v_mov_b32 v43, v131
    v_mov_b32 v12, 0x3f803f80
    s_nop 6
    v_cvt_pk_bf16_f32 v48, v112, v113
    v_cvt_pk_bf16_f32 v49, v114, v115
    v_cvt_pk_bf16_f32 v50, v116, v117
    v_cvt_pk_bf16_f32 v51, v118, v119
    v_cvt_pk_bf16_f32 v52, v120, v121
    v_cvt_pk_bf16_f32 v53, v122, v123
    v_cvt_pk_bf16_f32 v54, v124, v125
    v_cvt_pk_bf16_f32 v55, v126, v127
    v_cndmask_b32 v48, v48, v12, s[24:25]
    v_cndmask_b32 v49, v49, v12, s[24:25]
    v_cndmask_b32 v50, v50, v12, s[24:25]
    v_cndmask_b32 v51, v51, v12, s[24:25]
    v_cndmask_b32 v52, v52, v12, s[24:25]
    v_cndmask_b32 v53, v53, v12, s[24:25]
    v_cndmask_b32 v54, v54, v12, s[24:25]
    v_cndmask_b32 v55, v55, v12, s[24:25]
    v_cndmask_b32 v108, v108, v96, s[98:99]
    v_cndmask_b32 v109, v109, v96, s[98:99]
    v_cndmask_b32 v110, v110, v96, s[98:99]
    v_cndmask_b32 v111, v111, v96, s[98:99]
    v_max3_f32 v8, v96, v97, v98
    v_min3_f32 v10, v96, v97, v98
    v_max3_f32 v9, v99, v100, v101
    v_min3_f32 v11, v99, v100, v101
    v_max3_f32 v8, v8, v102, v103
    v_min3_f32 v10, v10, v102, v103
    v_max3_f32 v9, v9, v104, v105
    v_min3_f32 v11, v11, v104, v105
    v_max3_f32 v8, v8, v106, v107
    v_min3_f32 v10, v10, v106, v107
    v_max3_f32 v9, v9, v108, v109
    v_min3_f32 v11, v11, v108, v109
    v_max3_f32 v8, v8, v110, v111
    v_min3_f32 v10, v10, v110, v111
    v_max_f32 v8, v8, v9
    v_min_f32 v10, v10, v11
    v_mov_b32 v9, v8
    v_mov_b32 v11, v10
    s_nop 0
    v_permlane32_swap_b32 v8, v9
    v_permlane32_swap_b32 v10, v11
    v_max_f32 v8, v8, v9
    v_min_f32 v10, v10, v11
    v_mul_f32 v8, s4, v8
    v_mul_f32 v10, s4, v10
    v_pk_fma_f32 v[64:65], v[96:97], s[4:5], v[8:9] op_sel_hi:[1,1,0] neg_lo:[0,0,1] neg_hi:[0,0,1]
    v_pk_fma_f32 v[80:81], v[96:97], s[4:5], v[10:11] op_sel_hi:[1,1,0] neg_lo:[1,0,0] neg_hi:[1,0,0]
    v_pk_fma_f32 v[66:67], v[98:99], s[4:5], v[8:9] op_sel_hi:[1,1,0] neg_lo:[0,0,1] neg_hi:[0,0,1]
    v_pk_fma_f32 v[82:83], v[98:99], s[4:5], v[10:11] op_sel_hi:[1,1,0] neg_lo:[1,0,0] neg_hi:[1,0,0]
    v_pk_fma_f32 v[68:69], v[100:101], s[4:5], v[8:9] op_sel_hi:[1,1,0] neg_lo:[0,0,1] neg_hi:[0,0,1]
    v_pk_fma_f32 v[84:85], v[100:101], s[4:5], v[10:11] op_sel_hi:[1,1,0] neg_lo:[1,0,0] neg_hi:[1,0,0]
    v_pk_fma_f32 v[70:71], v[102:103], s[4:5], v[8:9] op_sel_hi:[1,1,0] neg_lo:[0,0,1] neg_hi:[0,0,1]
    v_pk_fma_f32 v[86:87], v[102:103], s[4:5], v[10:11] op_sel_hi:[1,1,0] neg_lo:[1,0,0] neg_hi:[1,0,0]
    v_pk_fma_f32 v[72:73], v[104:105], s[4:5], v[8:9] op_sel_hi:[1,1,0] neg_lo:[0,0,1] neg_hi:[0,0,1]
    v_pk_fma_f32 v[88:89], v[104:105], s[4:5], v[10:11] op_sel_hi:[1,1,0] neg_lo:[1,0,0] neg_hi:[1,0,0]
    v_pk_fma_f32 v[74:75], v[106:107], s[4:5], v[8:9] op_sel_hi:[1,1,0] neg_lo:[0,0,1] neg_hi:[0,0,1]
    v_pk_fma_f32 v[90:91], v[106:107], s[4:5], v[10:11] op_sel_hi:[1,1,0] neg_lo:[1,0,0] neg_hi:[1,0,0]
    v_pk_fma_f32 v[76:77], v[108:109], s[4:5], v[8:9] op_sel_hi:[1,1,0] neg_lo:[0,0,1] neg_hi:[0,0,1]
    v_pk_fma_f32 v[92:93], v[108:109], s[4:5], v[10:11] op_sel_hi:[1,1,0] neg_lo:[1,0,0] neg_hi:[1,0,0]
    v_pk_fma_f32 v[78:79], v[110:111], s[4:5], v[8:9] op_sel_hi:[1,1,0] neg_lo:[0,0,1] neg_hi:[0,0,1]
    v_pk_fma_f32 v[94:95], v[110:111], s[4:5], v[10:11] op_sel_hi:[1,1,0] neg_lo:[1,0,0] neg_hi:[1,0,0]
    v_exp_f32 v64, v64
    v_exp_f32 v80, v80
    v_exp_f32 v65, v65
    v_exp_f32 v81, v81
    v_exp_f32 v66, v66
    v_exp_f32 v82, v82
    v_exp_f32 v67, v67
    v_exp_f32 v83, v83
    v_exp_f32 v68, v68
    v_exp_f32 v84, v84
    v_exp_f32 v69, v69
    v_exp_f32 v85, v85
    v_exp_f32 v70, v70
    v_exp_f32 v86, v86
    v_exp_f32 v71, v71
    v_exp_f32 v87, v87
    v_exp_f32 v72, v72
    v_exp_f32 v88, v88
    v_exp_f32 v73, v73
    v_exp_f32 v89, v89
    v_exp_f32 v74, v74
    v_exp_f32 v90, v90
    v_exp_f32 v75, v75
    v_exp_f32 v91, v91
    v_exp_f32 v76, v76
    v_exp_f32 v92, v92
    v_exp_f32 v77, v77
    v_exp_f32 v93, v93
    v_exp_f32 v78, v78
    v_exp_f32 v94, v94
    v_exp_f32 v79, v79
    v_exp_f32 v95, v95
    v_pk_add_f32 v[32:33], v[64:65], v[66:67]
    v_pk_add_f32 v[34:35], v[76:77], v[78:79]
    v_pk_add_f32 v[36:37], v[80:81], v[82:83]
    v_pk_add_f32 v[38:39], v[92:93], v[94:95]
    v_pk_add_f32 v[32:33], v[32:33], v[68:69]
    v_cndmask_b32 v34, v34, 0, s[98:99]
    v_cndmask_b32 v35, v35, 0, s[98:99]
    v_pk_add_f32 v[36:37], v[36:37], v[84:85]
    v_cndmask_b32 v38, v38, 0, s[98:99]
    v_cndmask_b32 v39, v39, 0, s[98:99]
    v_pk_add_f32 v[32:33], v[32:33], v[70:71]
    v_pk_add_f32 v[34:35], v[34:35], v[72:73]
    v_pk_add_f32 v[36:37], v[36:37], v[86:87]
    v_pk_add_f32 v[38:39], v[38:39], v[88:89]
    v_pk_add_f32 v[32:33], v[32:33], v[74:75]
    v_pk_add_f32 v[36:37], v[36:37], v[90:91]
    v_pk_add_f32 v[32:33], v[32:33], v[34:35]
    v_pk_add_f32 v[36:37], v[36:37], v[38:39]
    v_add_f32 v8, v32, v33
    v_add_f32 v10, v36, v37
    v_mov_b32 v9, v8
    v_mov_b32 v11, v10
    s_nop 0
    v_permlane32_swap_b32 v8, v9
    v_permlane32_swap_b32 v10, v11
    v_add_f32 v8, v8, v9
    v_add_f32 v10, v10, v11
    v_rcp_f32 v8, v8
    v_rcp_f32 v10, v10
    v_cndmask_b32 v9, v8, 0, s[98:99]
    v_cndmask_b32 v11, v10, 0, s[98:99]
    v_pk_mul_f32 v[64:65], v[64:65], v[8:9] op_sel_hi:[1,0]
    v_pk_mul_f32 v[80:81], v[80:81], v[10:11] op_sel_hi:[1,0]
    v_pk_mul_f32 v[66:67], v[66:67], v[8:9] op_sel_hi:[1,0]
    v_pk_mul_f32 v[82:83], v[82:83], v[10:11] op_sel_hi:[1,0]
    v_pk_mul_f32 v[68:69], v[68:69], v[8:9] op_sel_hi:[1,0]
    v_pk_mul_f32 v[84:85], v[84:85], v[10:11] op_sel_hi:[1,0]
    v_pk_mul_f32 v[70:71], v[70:71], v[8:9] op_sel_hi:[1,0]
    v_pk_mul_f32 v[86:87], v[86:87], v[10:11] op_sel_hi:[1,0]
    v_pk_mul_f32 v[72:73], v[72:73], v[8:9] op_sel_hi:[1,0]
    v_pk_mul_f32 v[88:89], v[88:89], v[10:11] op_sel_hi:[1,0]
    v_pk_mul_f32 v[74:75], v[74:75], v[8:9] op_sel_hi:[1,0]
    v_pk_mul_f32 v[90:91], v[90:91], v[10:11] op_sel_hi:[1,0]
    v_pk_mul_f32 v[76:77], v[76:77], v[8:9] op_sel:[0,1] op_sel_hi:[1,1]
    v_pk_mul_f32 v[92:93], v[92:93], v[10:11] op_sel:[0,1] op_sel_hi:[1,1]
    v_pk_mul_f32 v[78:79], v[78:79], v[8:9] op_sel:[0,1] op_sel_hi:[1,1]
    v_pk_mul_f32 v[94:95], v[94:95], v[10:11] op_sel:[0,1] op_sel_hi:[1,1]
    v_cvt_pk_bf16_f32 v128, v64, v65
    v_cvt_pk_bf16_f32 v136, v80, v81
    v_cvt_pk_bf16_f32 v129, v66, v67
    v_cvt_pk_bf16_f32 v137, v82, v83
    v_cvt_pk_bf16_f32 v130, v68, v69
    v_cvt_pk_bf16_f32 v138, v84, v85
    v_cvt_pk_bf16_f32 v131, v70, v71
    v_cvt_pk_bf16_f32 v139, v86, v87
    v_cvt_pk_bf16_f32 v132, v72, v73
    v_cvt_pk_bf16_f32 v140, v88, v89
    v_cvt_pk_bf16_f32 v133, v74, v75
    v_cvt_pk_bf16_f32 v141, v90, v91
    v_cvt_pk_bf16_f32 v134, v76, v77
    v_cvt_pk_bf16_f32 v142, v92, v93
    v_cvt_pk_bf16_f32 v135, v78, v79
    v_cvt_pk_bf16_f32 v143, v94, v95
    v_mfma_f32_32x32x16_bf16 v[64:79], v[128:131], v[26:29], 0
    v_mfma_f32_32x32x16_bf16 v[64:79], v[132:135], v[40:43], v[64:79]
    v_mfma_f32_32x32x16_bf16 v[80:95], v[136:139], v[26:29], 0
    v_mfma_f32_32x32x16_bf16 v[80:95], v[140:143], v[40:43], v[80:95]
    s_mov_b32 s100, 160000
    s_nop 10
L_aw11:
    ds_read_b32 v13, v6 offset:8
    s_waitcnt lgkmcnt(0)
    v_cmp_ne_u32 vcc, 4, v13
    s_nop 4
    s_cbranch_vccz L_awd12
    s_sub_u32 s100, s100, 1
    s_cbranch_scc0 L_aw11
L_awd12:
    s_lshl_b32 s90, s75, 13
    s_add_u32 s90, s90, 98304
    v_add_u32 v8, s90, v2
    s_lshl_b32 s90, s75, 11
    s_add_u32 s90, s90, 98304
    v_add_u32 v9, s90, v2
    v_cvt_pk_bf16_f32 v128, v64, v65
    v_cvt_pk_bf16_f32 v129, v66, v67
    v_cvt_pk_bf16_f32 v130, v68, v69
    v_cvt_pk_bf16_f32 v131, v70, v71
    v_cvt_pk_bf16_f32 v132, v72, v73
    v_cvt_pk_bf16_f32 v133, v74, v75
    v_cvt_pk_bf16_f32 v134, v76, v77
    v_cvt_pk_bf16_f32 v135, v78, v79
    v_mfma_f32_32x32x16_bf16 v[96:111], v[128:131], v[48:51], 0
    s_nop 0
    v_mfma_f32_32x32x16_bf16 v[96:111], v[132:135], v[52:55], v[96:111]
    v_cvt_pk_bf16_f32 v136, v80, v81
    v_cvt_pk_bf16_f32 v137, v82, v83
    v_cvt_pk_bf16_f32 v138, v84, v85
    v_cvt_pk_bf16_f32 v139, v86, v87
    v_cvt_pk_bf16_f32 v140, v88, v89
    v_cvt_pk_bf16_f32 v141, v90, v91
    v_cvt_pk_bf16_f32 v142, v92, v93
    v_cvt_pk_bf16_f32 v143, v94, v95
    v_mfma_f32_32x32x16_bf16 v[112:127], v[136:139], v[48:51], 0
    s_nop 0
    v_mfma_f32_32x32x16_bf16 v[112:127], v[140:143], v[52:55], v[112:127]
    s_nop 0
    ds_write_b128 v8, v[96:99] offset:0
    ds_write_b128 v8, v[100:103] offset:1024
    ds_write_b128 v8, v[104:107] offset:2048
    ds_write_b128 v8, v[108:111] offset:3072
    s_nop 6
    ds_write_b128 v8, v[112:115] offset:4096
    ds_write_b128 v8, v[116:119] offset:5120
    ds_write_b128 v8, v[120:123] offset:6144
    ds_write_b128 v8, v[124:127] offset:7168
    s_waitcnt vmcnt(0)
    v_mov_b32 v13, 1
    s_mov_b64 exec, 1
    ds_add_u32 v6, v13 offset:12
    s_mov_b64 exec, -1
    s_mov_b32 s100, 160000
L_aw13:
    ds_read_b32 v13, v6 offset:12
    s_waitcnt lgkmcnt(0)
    v_cmp_ne_u32 vcc, 4, v13
    s_nop 4
    s_cbranch_vccz L_awd14
    s_sub_u32 s100, s100, 1
    s_cbranch_scc0 L_aw13
L_awd14:
    ds_read_b128 v[64:67], v9 offset:0
    ds_read_b128 v[68:71], v9 offset:8192
    ds_read_b128 v[72:75], v9 offset:16384
    ds_read_b128 v[76:79], v9 offset:24576
    ds_read_b128 v[80:83], v9 offset:1024
    ds_read_b128 v[84:87], v9 offset:9216
    ds_read_b128 v[88:91], v9 offset:17408
    ds_read_b128 v[92:95], v9 offset:25600
    v_mov_b32 v13, 1
    s_mov_b64 exec, 1
    ds_add_u32 v6, v13 offset:16
    s_mov_b64 exec, -1
    s_waitcnt lgkmcnt(5)
    v_add_f32 v64, v64, v68
    v_add_f32 v65, v65, v69
    v_add_f32 v72, v72, v76
    v_add_f32 v73, v73, v77
    v_add_f32 v66, v66, v70
    v_add_f32 v67, v67, v71
    v_add_f32 v74, v74, v78
    v_add_f32 v75, v75, v79
    v_add_f32 v64, v64, v72
    v_add_f32 v65, v65, v73
    v_add_f32 v66, v66, v74
    v_add_f32 v67, v67, v75
    buffer_atomic_add_f32 v64, v24, s[60:63], s9 offen offset:0
    buffer_atomic_add_f32 v65, v24, s[60:63], s9 offen offset:256
    buffer_atomic_add_f32 v66, v24, s[60:63], s9 offen offset:512
    buffer_atomic_add_f32 v67, v24, s[60:63], s9 offen offset:768
    s_waitcnt lgkmcnt(1)
    v_add_f32 v80, v80, v84
    v_add_f32 v81, v81, v85
    v_add_f32 v88, v88, v92
    v_add_f32 v89, v89, v93
    v_add_f32 v82, v82, v86
    v_add_f32 v83, v83, v87
    v_add_f32 v90, v90, v94
    v_add_f32 v91, v91, v95
    v_add_f32 v80, v80, v88
    v_add_f32 v81, v81, v89
    v_add_f32 v82, v82, v90
    v_add_f32 v83, v83, v91
    s_bitcmp1_b32 s75, 0
    s_cselect_b32 exec_hi, 0, -1
    buffer_atomic_add_f32 v80, v24, s[60:63], s9 offen offset:1024
    buffer_atomic_add_f32 v81, v24, s[60:63], s9 offen offset:1280
    buffer_atomic_add_f32 v82, v24, s[60:63], s9 offen offset:1536
    buffer_atomic_add_f32 v83, v24, s[60:63], s9 offen offset:1792
    s_mov_b32 exec_hi, -1
    v_add_u32 v14, 65536, v30
    v_add_u32 v22, s80, v14
    ds_read_b64_tr_b16 v[32:33], v22 offset:0
    ds_read_b64_tr_b16 v[34:35], v22 offset:256
    ds_read_b64_tr_b16 v[36:37], v22 offset:1024
    ds_read_b64_tr_b16 v[38:39], v22 offset:1280
    ds_read_b64_tr_b16 v[40:41], v22 offset:2048
    ds_read_b64_tr_b16 v[42:43], v22 offset:2304
    ds_read_b64_tr_b16 v[44:45], v22 offset:3072
    ds_read_b64_tr_b16 v[46:47], v22 offset:3328
    v_add_u32 v22, s81, v14
    ds_read_b64_tr_b16 v[48:49], v22 offset:0
    ds_read_b64_tr_b16 v[50:51], v22 offset:256
    ds_read_b64_tr_b16 v[52:53], v22 offset:1024
    ds_read_b64_tr_b16 v[54:55], v22 offset:1280
    s_waitcnt lgkmcnt(10)
    v_mfma_f32_32x32x16_bf16 v[96:111], v[32:35], v[144:147], 0
    ds_read_b64_tr_b16 v[32:33], v22 offset:2048
    ds_read_b64_tr_b16 v[34:35], v22 offset:2304
    s_waitcnt lgkmcnt(10)
    v_mfma_f32_32x32x16_bf16 v[96:111], v[36:39], v[148:151], v[96:111]
    ds_read_b64_tr_b16 v[36:37], v22 offset:3072
    ds_read_b64_tr_b16 v[38:39], v22 offset:3328
    s_waitcnt lgkmcnt(10)
    v_mfma_f32_32x32x16_bf16 v[96:111], v[40:43], v[152:155], v[96:111]
    v_add_u32 v22, s82, v14
    ds_read_b64_tr_b16 v[40:41], v22 offset:0
    ds_read_b64_tr_b16 v[42:43], v22 offset:256
    s_waitcnt lgkmcnt(10)
    v_mfma_f32_32x32x16_bf16 v[96:111], v[44:47], v[156:159], v[96:111]
    ds_read_b64_tr_b16 v[44:45], v22 offset:1024
    ds_read_b64_tr_b16 v[46:47], v22 offset:1280
    s_waitcnt lgkmcnt(10)
    v_mfma_f32_32x32x16_bf16 v[96:111], v[48:51], v[160:163], v[96:111]
    ds_read_b64_tr_b16 v[48:49], v22 offset:2048
    ds_read_b64_tr_b16 v[50:51], v22 offset:2304
    s_waitcnt lgkmcnt(10)
    v_mfma_f32_32x32x16_bf16 v[96:111], v[52:55], v[164:167], v[96:111]
    ds_read_b64_tr_b16 v[52:53], v22 offset:3072
    ds_read_b64_tr_b16 v[54:55], v22 offset:3328
    s_waitcnt lgkmcnt(10)
    v_mfma_f32_32x32x16_bf16 v[96:111], v[32:35], v[168:171], v[96:111]
    v_add_u32 v22, s83, v14
    ds_read_b64_tr_b16 v[32:33], v22 offset:0
    ds_read_b64_tr_b16 v[34:35], v22 offset:256
    s_waitcnt lgkmcnt(10)
    v_mfma_f32_32x32x16_bf16 v[96:111], v[36:39], v[172:175], v[96:111]
    ds_read_b64_tr_b16 v[36:37], v22 offset:1024
    ds_read_b64_tr_b16 v[38:39], v22 offset:1280
    s_waitcnt lgkmcnt(10)
    v_mfma_f32_32x32x16_bf16 v[96:111], v[40:43], v[176:179], v[96:111]
    ds_read_b64_tr_b16 v[40:41], v22 offset:2048
    ds_read_b64_tr_b16 v[42:43], v22 offset:2304
    s_waitcnt lgkmcnt(10)
    v_mfma_f32_32x32x16_bf16 v[96:111], v[44:47], v[180:183], v[96:111]
    ds_read_b64_tr_b16 v[44:45], v22 offset:3072
    ds_read_b64_tr_b16 v[46:47], v22 offset:3328
    s_waitcnt lgkmcnt(10)
    v_mfma_f32_32x32x16_bf16 v[96:111], v[48:51], v[184:187], v[96:111]
    v_add_u32 v22, s84, v14
    ds_read_b64_tr_b16 v[48:49], v22 offset:0
    ds_read_b64_tr_b16 v[50:51], v22 offset:256
    s_waitcnt lgkmcnt(10)
    v_mfma_f32_32x32x16_bf16 v[96:111], v[52:55], v[188:191], v[96:111]
    ds_read_b64_tr_b16 v[52:53], v22 offset:1024
    ds_read_b64_tr_b16 v[54:55], v22 offset:1280
    s_waitcnt lgkmcnt(10)
    v_mfma_f32_32x32x16_bf16 v[96:111], v[32:35], v[192:195], v[96:111]
    ds_read_b64_tr_b16 v[32:33], v22 offset:2048
    ds_read_b64_tr_b16 v[34:35], v22 offset:2304
    s_waitcnt lgkmcnt(10)
    v_mfma_f32_32x32x16_bf16 v[96:111], v[36:39], v[196:199], v[96:111]
    ds_read_b64_tr_b16 v[36:37], v22 offset:3072
    ds_read_b64_tr_b16 v[38:39], v22 offset:3328
    s_waitcnt lgkmcnt(10)
    v_mfma_f32_32x32x16_bf16 v[96:111], v[40:43], v[200:203], v[96:111]
    v_add_u32 v22, s85, v14
    ds_read_b64_tr_b16 v[40:41], v22 offset:0
    ds_read_b64_tr_b16 v[42:43], v22 offset:256
    s_waitcnt lgkmcnt(10)
    v_mfma_f32_32x32x16_bf16 v[96:111], v[44:47], v[204:207], v[96:111]
    ds_read_b64_tr_b16 v[44:45], v22 offset:1024
    ds_read_b64_tr_b16 v[46:47], v22 offset:1280
    s_waitcnt lgkmcnt(10)
    v_mfma_f32_32x32x16_bf16 v[96:111], v[48:51], v[208:211], v[96:111]
    ds_read_b64_tr_b16 v[48:49], v22 offset:2048
    ds_read_b64_tr_b16 v[50:51], v22 offset:2304
    s_waitcnt lgkmcnt(10)
    v_mfma_f32_32x32x16_bf16 v[96:111], v[52:55], v[212:215], v[96:111]
    ds_read_b64_tr_b16 v[52:53], v22 offset:3072
    ds_read_b64_tr_b16 v[54:55], v22 offset:3328
    s_waitcnt lgkmcnt(10)
    v_mfma_f32_32x32x16_bf16 v[96:111], v[32:35], v[216:219], v[96:111]
    v_add_u32 v22, s86, v14
    ds_read_b64_tr_b16 v[32:33], v22 offset:0
    ds_read_b64_tr_b16 v[34:35], v22 offset:256
    s_waitcnt lgkmcnt(10)
    v_mfma_f32_32x32x16_bf16 v[96:111], v[36:39], v[220:223], v[96:111]
    ds_read_b64_tr_b16 v[36:37], v22 offset:1024
    ds_read_b64_tr_b16 v[38:39], v22 offset:1280
    s_waitcnt lgkmcnt(10)
    v_mfma_f32_32x32x16_bf16 v[96:111], v[40:43], v[224:227], v[96:111]
    ds_read_b64_tr_b16 v[40:41], v22 offset:2048
    ds_read_b64_tr_b16 v[42:43], v22 offset:2304
    s_waitcnt lgkmcnt(10)
    v_mfma_f32_32x32x16_bf16 v[96:111], v[44:47], v[228:231], v[96:111]
    ds_read_b64_tr_b16 v[44:45], v22 offset:3072
    ds_read_b64_tr_b16 v[46:47], v22 offset:3328
    s_waitcnt lgkmcnt(10)
    v_mfma_f32_32x32x16_bf16 v[96:111], v[48:51], v[232:235], v[96:111]
    v_mov_b32 v13, 1
    s_mov_b64 exec, 1
    ds_add_u32 v6, v13 offset:24
    s_mov_b64 exec, -1
    s_waitcnt lgkmcnt(9)
    v_mfma_f32_32x32x16_bf16 v[96:111], v[52:55], v[236:239], v[96:111]
    s_waitcnt lgkmcnt(7)
    v_mfma_f32_32x32x16_bf16 v[96:111], v[32:35], v[240:243], v[96:111]
    s_waitcnt lgkmcnt(5)
    v_mfma_f32_32x32x16_bf16 v[96:111], v[36:39], v[244:247], v[96:111]
    s_waitcnt lgkmcnt(3)
    v_mfma_f32_32x32x16_bf16 v[96:111], v[40:43], v[248:251], v[96:111]
    s_waitcnt lgkmcnt(1)
    v_mfma_f32_32x32x16_bf16 v[96:111], v[44:47], v[252:255], v[96:111]
    s_waitcnt vmcnt(0)
    v_mov_b32 v13, 1
    v_lshlrev_b32 v5, 7, v1
    s_mov_b64 exec, 65535
    buffer_atomic_add v13, v5, s[60:63], s8 offen
    s_mov_b64 exec, -1
    s_nop 5
    v_cvt_pk_bf16_f32 v8, v108, v108
    v_cvt_pk_bf16_f32 v32, v96, v97
    v_cvt_pk_bf16_f32 v33, v98, v99
    v_cvt_pk_bf16_f32 v34, v100, v101
    v_cvt_pk_bf16_f32 v35, v102, v103
    v_cvt_pk_bf16_f32 v36, v104, v105
    v_cvt_pk_bf16_f32 v37, v106, v107
    v_cvt_pk_bf16_f32 v38, v108, v109
    v_cvt_pk_bf16_f32 v39, v110, v111
    v_mfma_f32_32x32x16_bf16 v[96:111], v[56:59], v[32:35], 0
    s_nop 0
    v_mfma_f32_32x32x16_bf16 v[96:111], v[60:63], v[36:39], v[96:111]
    v_lshlrev_b32 v8, 16, v8
    v_mul_f32 v8, s4, v8
    v_exp_f32 v8, -v8
    s_nop 0
    v_add_f32 v8, 1.0, v8
    v_rcp_f32 v8, v8
    s_nop 0
    v_cvt_pk_bf16_f32 v8, v8, v8
    v_lshlrev_b32 v31, 16, v8
    s_mov_b32 exec_lo, 0
    buffer_store_dword v31, v24, s[60:63], s88 offen sc1
    s_mov_b32 exec_lo, -1
    v_cvt_pk_bf16_f32 v97, v96, v97
    v_lshlrev_b32 v96, 16, v97
    v_and_b32 v97, 0xffff0000, v97
    v_cvt_pk_bf16_f32 v99, v98, v99
    v_lshlrev_b32 v98, 16, v99
    v_and_b32 v99, 0xffff0000, v99
    v_cvt_pk_bf16_f32 v101, v100, v101
    v_lshlrev_b32 v100, 16, v101
    v_and_b32 v101, 0xffff0000, v101
    v_cvt_pk_bf16_f32 v103, v102, v103
    v_lshlrev_b32 v102, 16, v103
    v_and_b32 v103, 0xffff0000, v103
    v_cvt_pk_bf16_f32 v105, v104, v105
    v_lshlrev_b32 v104, 16, v105
    v_and_b32 v105, 0xffff0000, v105
    v_cvt_pk_bf16_f32 v107, v106, v107
    v_lshlrev_b32 v106, 16, v107
    v_and_b32 v107, 0xffff0000, v107
    v_cvt_pk_bf16_f32 v109, v108, v109
    v_lshlrev_b32 v108, 16, v109
    v_and_b32 v109, 0xffff0000, v109
    v_cvt_pk_bf16_f32 v111, v110, v111
    v_lshlrev_b32 v110, 16, v111
    v_and_b32 v111, 0xffff0000, v111
    v_cndmask_b32 v108, v108, v96, s[98:99]
    v_cndmask_b32 v109, v109, v96, s[98:99]
    v_cndmask_b32 v110, v110, v96, s[98:99]
    v_cndmask_b32 v111, v111, v96, s[98:99]
    v_max3_f32 v8, v96, v97, v98
    v_min3_f32 v10, v96, v97, v98
    v_max3_f32 v9, v99, v100, v101
    v_min3_f32 v11, v99, v100, v101
    v_max3_f32 v8, v8, v102, v103
    v_min3_f32 v10, v10, v102, v103
    v_max3_f32 v9, v9, v104, v105
    v_min3_f32 v11, v11, v104, v105
    v_max3_f32 v8, v8, v106, v107
    v_min3_f32 v10, v10, v106, v107
    v_max3_f32 v9, v9, v108, v109
    v_min3_f32 v11, v11, v108, v109
    v_max3_f32 v8, v8, v110, v111
    v_min3_f32 v10, v10, v110, v111
    v_max_f32 v8, v8, v9
    v_min_f32 v10, v10, v11
    v_mov_b32 v9, v8
    v_mov_b32 v11, v10
    s_nop 0
    v_permlane32_swap_b32 v8, v9
    v_permlane32_swap_b32 v10, v11
    v_max_f32 v8, v8, v9
    v_min_f32 v10, v10, v11
    v_mul_f32 v8, s4, v8
    v_mul_f32 v10, s4, v10
    v_fma_f32 v64, v96, s4, -v8
    v_fma_f32 v80, -v96, s4, v10
    v_fma_f32 v65, v97, s4, -v8
    v_fma_f32 v81, -v97, s4, v10
    v_fma_f32 v66, v98, s4, -v8
    v_fma_f32 v82, -v98, s4, v10
    v_fma_f32 v67, v99, s4, -v8
    v_fma_f32 v83, -v99, s4, v10
    v_fma_f32 v68, v100, s4, -v8
    v_fma_f32 v84, -v100, s4, v10
    v_fma_f32 v69, v101, s4, -v8
    v_fma_f32 v85, -v101, s4, v10
    v_fma_f32 v70, v102, s4, -v8
    v_fma_f32 v86, -v102, s4, v10
    v_fma_f32 v71, v103, s4, -v8
    v_fma_f32 v87, -v103, s4, v10
    v_fma_f32 v72, v104, s4, -v8
    v_fma_f32 v88, -v104, s4, v10
    v_fma_f32 v73, v105, s4, -v8
    v_fma_f32 v89, -v105, s4, v10
    v_fma_f32 v74, v106, s4, -v8
    v_fma_f32 v90, -v106, s4, v10
    v_fma_f32 v75, v107, s4, -v8
    v_fma_f32 v91, -v107, s4, v10
    v_fma_f32 v76, v108, s4, -v8
    v_fma_f32 v92, -v108, s4, v10
    v_fma_f32 v77, v109, s4, -v8
    v_fma_f32 v93, -v109, s4, v10
    v_fma_f32 v78, v110, s4, -v8
    v_fma_f32 v94, -v110, s4, v10
    v_fma_f32 v79, v111, s4, -v8
    v_fma_f32 v95, -v111, s4, v10
    v_exp_f32 v64, v64
    v_exp_f32 v80, v80
    v_exp_f32 v65, v65
    v_exp_f32 v81, v81
    v_exp_f32 v66, v66
    v_exp_f32 v82, v82
    v_exp_f32 v67, v67
    v_exp_f32 v83, v83
    v_exp_f32 v68, v68
    v_exp_f32 v84, v84
    v_exp_f32 v69, v69
    v_exp_f32 v85, v85
    v_exp_f32 v70, v70
    v_exp_f32 v86, v86
    v_exp_f32 v71, v71
    v_exp_f32 v87, v87
    v_exp_f32 v72, v72
    v_exp_f32 v88, v88
    v_exp_f32 v73, v73
    v_exp_f32 v89, v89
    v_exp_f32 v74, v74
    v_exp_f32 v90, v90
    v_exp_f32 v75, v75
    v_exp_f32 v91, v91
    v_exp_f32 v76, v76
    v_exp_f32 v92, v92
    v_exp_f32 v77, v77
    v_exp_f32 v93, v93
    v_exp_f32 v78, v78
    v_exp_f32 v94, v94
    v_exp_f32 v79, v79
    v_exp_f32 v95, v95
    v_add_f32 v32, v64, v66
    v_add_f32 v33, v65, v67
    v_add_f32 v34, v76, v78
    v_add_f32 v35, v77, v79
    v_add_f32 v36, v80, v82
    v_add_f32 v37, v81, v83
    v_add_f32 v38, v92, v94
    v_add_f32 v39, v93, v95
    v_add_f32 v32, v32, v68
    v_add_f32 v33, v33, v69
    v_cndmask_b32 v34, v34, 0, s[98:99]
    v_cndmask_b32 v35, v35, 0, s[98:99]
    v_add_f32 v36, v36, v84
    v_add_f32 v37, v37, v85
    v_cndmask_b32 v38, v38, 0, s[98:99]
    v_cndmask_b32 v39, v39, 0, s[98:99]
    v_add_f32 v32, v32, v70
    v_add_f32 v33, v33, v71
    v_add_f32 v34, v34, v72
    v_add_f32 v35, v35, v73
    v_add_f32 v36, v36, v86
    v_add_f32 v37, v37, v87
    v_add_f32 v38, v38, v88
    v_add_f32 v39, v39, v89
    v_add_f32 v32, v32, v74
    v_add_f32 v33, v33, v75
    v_add_f32 v36, v36, v90
    v_add_f32 v37, v37, v91
    v_add_f32 v32, v32, v34
    v_add_f32 v33, v33, v35
    v_add_f32 v36, v36, v38
    v_add_f32 v37, v37, v39
    v_add_f32 v8, v32, v33
    v_add_f32 v10, v36, v37
    v_mov_b32 v9, v8
    v_mov_b32 v11, v10
    s_nop 0
    v_permlane32_swap_b32 v8, v9
    v_permlane32_swap_b32 v10, v11
    v_add_f32 v8, v8, v9
    v_add_f32 v10, v10, v11
    v_rcp_f32 v8, v8
    v_rcp_f32 v10, v10
    v_cndmask_b32 v9, v8, 0, s[98:99]
    v_cndmask_b32 v11, v10, 0, s[98:99]
    v_mul_f32 v64, v64, v8
    v_mul_f32 v65, v65, v8
    v_mul_f32 v80, v80, v10
    v_mul_f32 v81, v81, v10
    v_mul_f32 v66, v66, v8
    v_mul_f32 v67, v67, v8
    v_mul_f32 v82, v82, v10
    v_mul_f32 v83, v83, v10
    v_mul_f32 v68, v68, v8
    v_mul_f32 v69, v69, v8
    v_mul_f32 v84, v84, v10
    v_mul_f32 v85, v85, v10
    v_mul_f32 v70, v70, v8
    v_mul_f32 v71, v71, v8
    v_mul_f32 v86, v86, v10
    v_mul_f32 v87, v87, v10
    v_mul_f32 v72, v72, v8
    v_mul_f32 v73, v73, v8
    v_mul_f32 v88, v88, v10
    v_mul_f32 v89, v89, v10
    v_mul_f32 v74, v74, v8
    v_mul_f32 v75, v75, v8
    v_mul_f32 v90, v90, v10
    v_mul_f32 v91, v91, v10
    v_mul_f32 v76, v76, v9
    v_mul_f32 v77, v77, v9
    v_mul_f32 v92, v92, v11
    v_mul_f32 v93, v93, v11
    v_mul_f32 v78, v78, v9
    v_mul_f32 v79, v79, v9
    v_mul_f32 v94, v94, v11
    v_mul_f32 v95, v95, v11
    v_cvt_pk_bf16_f32 v128, v64, v65
    v_cvt_pk_bf16_f32 v136, v80, v81
    v_cvt_pk_bf16_f32 v129, v66, v67
    v_cvt_pk_bf16_f32 v137, v82, v83
    v_cvt_pk_bf16_f32 v130, v68, v69
    v_cvt_pk_bf16_f32 v138, v84, v85
    v_cvt_pk_bf16_f32 v131, v70, v71
    v_cvt_pk_bf16_f32 v139, v86, v87
    v_cvt_pk_bf16_f32 v132, v72, v73
    v_cvt_pk_bf16_f32 v140, v88, v89
    v_cvt_pk_bf16_f32 v133, v74, v75
    v_cvt_pk_bf16_f32 v141, v90, v91
    v_cvt_pk_bf16_f32 v134, v76, v77
    v_cvt_pk_bf16_f32 v142, v92, v93
    v_cvt_pk_bf16_f32 v135, v78, v79
    v_cvt_pk_bf16_f32 v143, v94, v95
    s_load_dword s16, s[40:41], s34 offset:0 glc
    s_mov_b32 s100, 20000
L_poll15:
    s_waitcnt lgkmcnt(0)
    s_cmp_eq_u32 s16, 16
    s_cbranch_scc1 L_polld16
    s_sub_u32 s100, s100, 1
    s_cbranch_scc1 L_polld16
    s_sleep 2
    s_load_dword s16, s[40:41], s34 offset:0 glc
    s_branch L_poll15
L_polld16:
    buffer_load_dword v64, v24, s[60:63], s9 offen offset:0 sc1
    buffer_load_dword v65, v24, s[60:63], s9 offen offset:256 sc1
    buffer_load_dword v66, v24, s[60:63], s9 offen offset:512 sc1
    buffer_load_dword v67, v24, s[60:63], s9 offen offset:768 sc1
    buffer_load_dword v68, v24, s[60:63], s9 offen offset:1024 sc1
    buffer_load_dword v69, v24, s[60:63], s9 offen offset:1280 sc1
    buffer_load_dword v70, v24, s[60:63], s9 offen offset:1536 sc1
    buffer_load_dword v71, v24, s[60:63], s9 offen offset:1792 sc1
    s_lshl_b32 s90, s75, 10
    v_add_u32 v9, 159744, v2
    v_add_u32 v8, s90, v9
    s_waitcnt vmcnt(0)
    v_cvt_pk_bf16_f32 v32, v64, v65
    v_cvt_pk_bf16_f32 v33, v66, v67
    v_cvt_pk_bf16_f32 v34, v68, v69
    v_cvt_pk_bf16_f32 v35, v70, v71
    ds_write_b128 v8, v[32:35]
    v_mov_b32 v13, 1
    s_mov_b64 exec, 1
    ds_add_u32 v6, v13 offset:20
    s_mov_b64 exec, -1
    s_mov_b32 s100, 160000
L_aw17:
    ds_read_b32 v13, v6 offset:20
    s_waitcnt lgkmcnt(0)
    v_cmp_ne_u32 vcc, 4, v13
    s_nop 4
    s_cbranch_vccz L_awd18
    s_sub_u32 s100, s100, 1
    s_cbranch_scc0 L_aw17
L_awd18:
    ds_read_b128 v[32:35], v9 offset:0
    ds_read_b128 v[36:39], v9 offset:1024
    ds_read_b128 v[40:43], v9 offset:2048
    ds_read_b128 v[44:47], v9 offset:3072
    s_waitcnt lgkmcnt(3)
    v_mfma_f32_32x32x16_bf16 v[96:111], v[32:35], v[128:131], 0
    s_waitcnt lgkmcnt(2)
    v_mfma_f32_32x32x16_bf16 v[96:111], v[36:39], v[132:135], v[96:111]
    s_waitcnt lgkmcnt(1)
    v_mfma_f32_32x32x16_bf16 v[96:111], v[40:43], v[136:139], v[96:111]
    s_waitcnt lgkmcnt(0)
    v_mfma_f32_32x32x16_bf16 v[96:111], v[44:47], v[140:143], v[96:111]
    s_nop 11
    v_cvt_pk_bf16_f32 v8, v108, v108
    v_cvt_pk_bf16_f32 v32, v96, v97
    v_cvt_pk_bf16_f32 v33, v98, v99
    v_cvt_pk_bf16_f32 v34, v100, v101
    v_cvt_pk_bf16_f32 v35, v102, v103
    v_cvt_pk_bf16_f32 v36, v104, v105
    v_cvt_pk_bf16_f32 v37, v106, v107
    v_cvt_pk_bf16_f32 v38, v108, v109
    v_cvt_pk_bf16_f32 v39, v110, v111
    v_lshlrev_b32 v8, 16, v8
    v_add_f32 v8, 0x358637bd, v8
    v_cvt_pk_bf16_f32 v8, v8, v8
    v_lshlrev_b32 v8, 16, v8
    v_rcp_f32 v8, v8
    v_lshlrev_b32 v96, 16, v32
    v_and_b32 v97, 0xffff0000, v32
    v_lshlrev_b32 v98, 16, v33
    v_and_b32 v99, 0xffff0000, v33
    v_lshlrev_b32 v100, 16, v34
    v_and_b32 v101, 0xffff0000, v34
    v_lshlrev_b32 v102, 16, v35
    v_and_b32 v103, 0xffff0000, v35
    v_mul_f32 v8, v8, v31
    v_mov_b32 v9, v8
    v_lshlrev_b32 v104, 16, v36
    v_and_b32 v105, 0xffff0000, v36
    v_lshlrev_b32 v106, 16, v37
    v_and_b32 v107, 0xffff0000, v37
    v_lshlrev_b32 v108, 16, v38
    v_and_b32 v109, 0xffff0000, v38
    v_lshlrev_b32 v110, 16, v39
    v_and_b32 v111, 0xffff0000, v39
    v_permlane32_swap_b32 v9, v8
    v_mul_f32 v96, v96, v8
    v_mul_f32 v97, v97, v8
    v_mul_f32 v98, v98, v8
    v_mul_f32 v99, v99, v8
    v_mul_f32 v100, v100, v8
    v_mul_f32 v101, v101, v8
    v_mul_f32 v102, v102, v8
    v_mul_f32 v103, v103, v8
    v_mul_f32 v104, v104, v8
    v_mul_f32 v105, v105, v8
    v_mul_f32 v106, v106, v8
    v_mul_f32 v107, v107, v8
    v_mul_f32 v108, v108, v8
    v_mul_f32 v109, v109, v8
    v_mul_f32 v110, v110, v8
    v_mul_f32 v111, v111, v8
    v_cvt_pk_bf16_f32 v32, v96, v97
    v_cvt_pk_bf16_f32 v33, v98, v99
    v_cvt_pk_bf16_f32 v34, v100, v101
    v_cvt_pk_bf16_f32 v35, v102, v103
    v_cvt_pk_bf16_f32 v36, v104, v105
    v_cvt_pk_bf16_f32 v37, v106, v107
    v_cvt_pk_bf16_f32 v38, v108, v109
    v_cvt_pk_bf16_f32 v39, v110, v111
    v_cndmask_b32 v38, v38, 0, s[98:99]
    v_cndmask_b32 v39, v39, 0, s[98:99]
    buffer_store_dwordx4 v[32:35], v2, s[60:63], s11 offen sc1
    buffer_store_dwordx4 v[36:39], v2, s[60:63], s11 offen offset:1024 sc1
    s_waitcnt vmcnt(0)
    v_mov_b32 v13, 1
    v_lshlrev_b32 v5, 7, v1
    s_mov_b64 exec, 127
    buffer_atomic_add v13, v5, s[60:63], s76 offen
    s_mov_b64 exec, -1
    s_cmp_eq_u32 s101, 0
    s_cbranch_scc1 L_fin
    s_branch L_red
L_M:
    s_setprio 2
    s_waitcnt lgkmcnt(0)
    s_load_dword s42, s[40:41], 0
    s_mov_b32 s68, s20
    s_and_b32 s69, s21, 0xffff
    s_mov_b32 s70, 25088
    s_mov_b32 s71, 0x20000
    s_mul_i32 s90, s73, 1568
    s_mul_i32 s91, s75, 400
    s_add_u32 s90, s90, s91
    s_add_u32 m0, s91, 155648
    s_mov_b64 exec, 0x1ffffff
    buffer_load_dwordx4 v2, s[68:71], s90 offen lds
    s_mov_b64 exec, -1
    v_mov_b32 v6, 157696
    v_mov_b32 v8, 0
    v_lshl_add_u32 v9, v1, 2, v6
    ds_write_b32 v9, v8
    s_cmp_lt_u32 s73, 14
    s_cbranch_scc1 L_mset
    s_mov_b32 s68, s18
    s_and_b32 s69, s19, 0xffff
    s_mov_b32 s70, 1204224
    s_mov_b32 s71, 0x20000
    s_lshl_b32 s8, s72, 1
    s_add_u32 s8, s8, s73
    s_sub_u32 s8, s8, 14
    s_mul_i32 s88, s8, 14
    s_lshl_b32 s95, s75, 1
    s_add_u32 s88, s88, s95
    v_lshrrev_b32 v8, 3, v1
    v_bfe_u32 v9, v1, 2, 1
    v_and_b32 v10, 3, v1
    v_mul_u32_u24 v11, 56, v8
    v_mul_u32_u24 v12, 2688, v9
    v_add_u32 v11, v11, v12
    v_lshl_add_u32 v11, v10, 4, v11
    s_mul_i32 s95, s88, 2688
    v_lshlrev_b32 v12, 1, v9
    s_lshl_b32 s96, s88, 1
    s_add_u32 s97, s95, 21504
    s_cmp_eq_u32 s75, 3
    s_cselect_b32 s97, 0x7000000, s97
    s_cselect_b32 s77, s97, 512
    buffer_load_dwordx4 v[104:107], v11, s[68:71], s95 offen offset:896
    buffer_load_dwordx4 v[108:111], v11, s[68:71], s95 offen offset:1344
    buffer_load_dwordx4 v[112:115], v11, s[68:71], s95 offen offset:1792
    buffer_load_dwordx4 v[116:119], v11, s[68:71], s95 offen offset:2240
    buffer_load_dwordx4 v[128:131], v11, s[68:71], s97 offen offset:896
    buffer_load_dwordx4 v[132:135], v11, s[68:71], s97 offen offset:1344
    buffer_load_dwordx4 v[136:139], v11, s[68:71], s97 offen offset:1792
    buffer_load_dwordx4 v[140:143], v11, s[68:71], s97 offen offset:2240
    s_mov_b32 s44, s34
    s_and_b32 s45, s35, 0xffff
    s_mov_b32 s46, 896
    s_mov_b32 s47, 0x20000
    buffer_load_ushort v144, v12, s[44:47], s96 offen
    buffer_load_ushort v145, v12, s[44:47], s96 offen offset:16
    buffer_load_dwordx4 v[96:99], v11, s[68:71], s95 offen offset:0
    buffer_load_dwordx4 v[100:103], v11, s[68:71], s95 offen offset:448
    buffer_load_dwordx4 v[120:123], v11, s[68:71], s97 offen offset:0
    buffer_load_dwordx4 v[124:127], v11, s[68:71], s97 offen offset:448
    s_mov_b32 s60, s40
    s_and_b32 s61, s41, 0xffff
    s_mov_b32 s62, 14680064
    s_mov_b32 s63, 0x20000
    s_mov_b32 s96, 86016
    v_mul_lo_u32 v146, v8, s96
    v_and_b32 v9, 7, v1
    v_lshl_add_u32 v146, v9, 4, v146
    v_cmp_eq_u32 vcc, 3, v10
    s_lshl_b32 s88, s88, 6
    s_add_u32 s88, s88, 1048576
    v_mov_b32 v148, 0
    v_mov_b32 v149, 0
    v_mov_b32 v150, 0
    v_mov_b32 v151, 0
    s_lshl_b32 s95, s8, 2
    s_add_u32 s95, s95, s75
    s_lshl_b32 s97, s95, 12
    s_lshl_b32 s95, s95, 10
    s_add_u32 s95, s95, 2621440
    s_add_u32 s97, s97, 3145728
    v_lshlrev_b32 v8, 7, v1
    buffer_store_dwordx4 v[148:151], v2, s[60:63], s95 offen sc1
    s_mov_b32 exec_hi, 0
    buffer_store_dword v148, v8, s[60:63], s97 offen sc1
    s_mov_b32 exec_hi, -1
    s_lshl_b32 s8, s8, 7
    s_add_u32 s8, s8, 32768
    s_add_u32 s76, s8, 4096
    s_cmp_eq_u32 s75, 3
    s_cselect_b32 s8, s8, 0x7000000
    s_cselect_b32 s76, s76, 0x7000000
    s_waitcnt lgkmcnt(0)
    s_add_u32 s78, s42, 0x9E3779B9
    s_mov_b32 s79, s78
    v_mov_b32 v4, s78
    s_waitcnt vmcnt(15)
    v_cndmask_b32 v106, v106, 0, vcc
    v_cndmask_b32 v107, v107, 0, vcc
    s_add_u32 s96, s88, 28672
    buffer_store_dwordx4 v[104:107], v146, s[60:63], s96 offen sc1
    s_waitcnt vmcnt(15)
    v_cndmask_b32 v110, v110, 0, vcc
    v_cndmask_b32 v111, v111, 0, vcc
    s_add_u32 s96, s88, 716800
    buffer_store_dwordx4 v[108:111], v146, s[60:63], s96 offen sc1
    s_waitcnt vmcnt(15)
    v_cndmask_b32 v114, v114, 0, vcc
    v_cndmask_b32 v115, v115, 0, vcc
    s_add_u32 s96, s88, 57344
    buffer_store_dwordx4 v[112:115], v146, s[60:63], s96 offen sc1
    s_waitcnt vmcnt(15)
    v_cndmask_b32 v118, v118, 0, vcc
    v_cndmask_b32 v119, v119, 0, vcc
    s_add_u32 s96, s88, 745472
    buffer_store_dwordx4 v[116:119], v146, s[60:63], s96 offen sc1
    s_waitcnt vmcnt(15)
    v_cndmask_b32 v130, v130, 0, vcc
    v_cndmask_b32 v131, v131, 0, vcc
    s_add_u32 s96, s88, 28672
    s_add_u32 s96, s96, s77
    buffer_store_dwordx4 v[128:131], v146, s[60:63], s96 offen sc1
    s_waitcnt vmcnt(15)
    v_cndmask_b32 v134, v134, 0, vcc
    v_cndmask_b32 v135, v135, 0, vcc
    s_add_u32 s96, s88, 716800
    s_add_u32 s96, s96, s77
    buffer_store_dwordx4 v[132:135], v146, s[60:63], s96 offen sc1
    s_waitcnt vmcnt(15)
    v_cndmask_b32 v138, v138, 0, vcc
    v_cndmask_b32 v139, v139, 0, vcc
    s_add_u32 s96, s88, 57344
    s_add_u32 s96, s96, s77
    buffer_store_dwordx4 v[136:139], v146, s[60:63], s96 offen sc1
    s_waitcnt vmcnt(15)
    v_cndmask_b32 v142, v142, 0, vcc
    v_cndmask_b32 v143, v143, 0, vcc
    s_add_u32 s96, s88, 745472
    s_add_u32 s96, s96, s77
    buffer_store_dwordx4 v[140:143], v146, s[60:63], s96 offen sc1
    s_waitcnt vmcnt(13)
    v_cndmask_b32 v98, v98, v144, vcc
    v_cndmask_b32 v99, v99, 0, vcc
    s_add_u32 s96, s88, 0
    buffer_store_dwordx4 v[96:99], v146, s[60:63], s96 offen sc1
    s_waitcnt vmcnt(13)
    v_cndmask_b32 v102, v102, v144, vcc
    v_cndmask_b32 v103, v103, 0, vcc
    s_add_u32 s96, s88, 688128
    buffer_store_dwordx4 v[100:103], v146, s[60:63], s96 offen sc1
    s_waitcnt vmcnt(13)
    v_cndmask_b32 v122, v122, v145, vcc
    v_cndmask_b32 v123, v123, 0, vcc
    s_add_u32 s96, s88, 0
    s_add_u32 s96, s96, s77
    buffer_store_dwordx4 v[120:123], v146, s[60:63], s96 offen sc1
    s_waitcnt vmcnt(13)
    v_cndmask_b32 v126, v126, v145, vcc
    v_cndmask_b32 v127, v127, 0, vcc
    s_add_u32 s96, s88, 688128
    s_add_u32 s96, s96, s77
    buffer_store_dwordx4 v[124:127], v146, s[60:63], s96 offen sc1
    s_barrier
    s_waitcnt vmcnt(4)
    s_barrier
    s_mov_b64 exec, 1
    buffer_store_dword v4, v1, s[60:63], s8 offen sc1
    s_mov_b64 exec, -1
    s_waitcnt vmcnt(1)
    v_mov_b32 v13, 1
    s_mov_b64 exec, 1
    ds_add_u32 v6, v13 offset:40
    s_mov_b64 exec, -1
    s_mov_b32 s100, 160000
L_aw19:
    ds_read_b32 v13, v6 offset:40
    s_waitcnt lgkmcnt(0)
    v_cmp_ne_u32 vcc, 4, v13
    s_nop 4
    s_cbranch_vccz L_awd20
    s_sub_u32 s100, s100, 1
    s_cbranch_scc0 L_aw19
L_awd20:
    s_mov_b64 exec, 1
    buffer_store_dword v4, v1, s[60:63], s76 offen sc1
    s_mov_b64 exec, -1
    v_mov_b32 v13, 1
    s_mov_b64 exec, 1
    ds_add_u32 v6, v13 offset:0
    s_mov_b64 exec, -1
    v_mov_b32 v13, 1
    s_mov_b64 exec, 1
    ds_add_u32 v6, v13 offset:28
    s_mov_b64 exec, -1
    s_setprio 0
L_mset:
    s_mov_b32 s60, s40
    s_and_b32 s61, s41, 0xffff
    s_mov_b32 s62, 14680064
    s_mov_b32 s63, 0x20000
    s_mov_b32 s56, s22
    s_and_b32 s57, s23, 0xffff
    s_mov_b32 s58, 401408
    s_mov_b32 s59, 0x20000
    s_mov_b32 s64, s36
    s_and_b32 s65, s37, 0xffff
    s_mov_b32 s66, 1835008
    s_mov_b32 s67, 0x20000
    s_mov_b32 s52, s30
    s_and_b32 s53, s31, 0xffff
    s_mov_b32 s54, 1605632
    s_mov_b32 s55, 0x20000
    s_and_b32 s90, s2, 7
    s_lshr_b32 s91, s2, 3
    s_mul_i32 s92, s91, 37
    s_lshr_b32 s92, s92, 8
    s_mul_i32 s93, s92, 7
    s_sub_u32 s43, s91, s93
    s_lshl_b32 s92, s92, 1
    s_lshl_b32 s93, s90, 3
    s_add_u32 s3, s92, s93
    s_cmp_lt_u32 s91, 28
    s_cselect_b32 s101, 1, 0
    s_and_b32 s92, s75, 1
    s_mul_i32 s93, s75, 7
    s_add_u32 s94, s93, s92
    s_cmp_eq_u32 s92, 0
    s_cselect_b32 s92, 6, 0
    s_add_u32 s92, s92, s93
    s_lshl_b32 s90, s43, 7
    s_mul_i32 s10, s94, 57344
    s_add_u32 s10, s10, s90
    s_mul_i32 s13, s92, 57344
    s_add_u32 s13, s13, s90
    s_lshl_b32 s14, s75, 13
    v_lshrrev_b32 v8, 3, v1
    v_and_b32 v9, 7, v1
    v_bfe_u32 v10, v1, 4, 1
    v_lshlrev_b32 v10, 2, v10
    v_xor_b32 v9, v9, v10
    v_mul_u32_u24 v8, 896, v8
    v_lshl_add_u32 v18, v9, 4, v8
    v_add_u32 v19, 6144, v18
    v_add_u32 v20, 12288, v18
    v_add_u32 v21, 18432, v18
    v_mov_b32 v6, 157696
    s_mul_i32 s90, s3, 114688
    s_add_u32 s90, s90, 6815744
    s_lshl_b32 s9, s94, 12
    s_add_u32 s9, s9, s90
    s_lshl_b32 s12, s92, 12
    s_add_u32 s12, s12, s90
    v_mov_b32 v224, 0
    v_mov_b32 v225, 0
    v_mov_b32 v226, 0
    v_mov_b32 v227, 0
    v_mov_b32 v228, 0
    v_mov_b32 v229, 0
    v_mov_b32 v230, 0
    v_mov_b32 v231, 0
    v_mov_b32 v232, 0
    v_mov_b32 v233, 0
    v_mov_b32 v234, 0
    v_mov_b32 v235, 0
    v_mov_b32 v236, 0
    v_mov_b32 v237, 0
    v_mov_b32 v238, 0
    v_mov_b32 v239, 0
    v_mov_b32 v240, 0
    v_mov_b32 v241, 0
    v_mov_b32 v242, 0
    v_mov_b32 v243, 0
    v_mov_b32 v244, 0
    v_mov_b32 v245, 0
    v_mov_b32 v246, 0
    v_mov_b32 v247, 0
    v_mov_b32 v248, 0
    v_mov_b32 v249, 0
    v_mov_b32 v250, 0
    v_mov_b32 v251, 0
    v_mov_b32 v252, 0
    v_mov_b32 v253, 0
    v_mov_b32 v254, 0
    v_mov_b32 v255, 0
    v_mov_b32 v124, 0
    v_mov_b32 v125, 0
    v_mov_b32 v126, 0
    v_mov_b32 v127, 0
    v_mov_b32 v128, 0
    v_mov_b32 v129, 0
    v_mov_b32 v130, 0
    v_mov_b32 v131, 0
    v_mov_b32 v132, 0
    v_mov_b32 v133, 0
    v_mov_b32 v134, 0
    v_mov_b32 v135, 0
    v_lshlrev_b32 v8, 1, v1
    s_mov_b32 exec_hi, 0
    v_mov_b32 v124, 0x3f80
    s_mov_b32 s68, s28
    s_and_b32 s69, s29, 0xffff
    s_mov_b32 s70, 3584
    s_mov_b32 s71, 0x20000
    v_bfe_u32 v9, v1, 2, 1
    v_bfe_u32 v10, v1, 3, 1
    v_and_b32 v11, 3, v1
    v_lshl_add_u32 v11, v9, 3, v11
    v_lshl_add_u32 v11, v10, 2, v11
    v_lshlrev_b32 v11, 1, v11
    s_mov_b32 exec_lo, 0xffff
    buffer_load_ushort v224, v11, s[68:71], s89 offen offset:0
    buffer_load_ushort v228, v11, s[68:71], s89 offen offset:32
    buffer_load_ushort v232, v11, s[68:71], s89 offen offset:64
    buffer_load_ushort v236, v11, s[68:71], s89 offen offset:96
    buffer_load_ushort v240, v11, s[68:71], s89 offen offset:128
    buffer_load_ushort v244, v11, s[68:71], s89 offen offset:160
    buffer_load_ushort v248, v11, s[68:71], s89 offen offset:192
    buffer_load_ushort v252, v11, s[68:71], s89 offen offset:224
    s_mov_b32 exec_lo, -1
    s_mov_b32 s68, s32
    s_and_b32 s69, s33, 0xffff
    s_mov_b32 s70, 896
    s_mov_b32 s71, 0x20000
    s_lshl_b32 s90, s43, 7
    s_lshl_b32 s91, s75, 10
    s_add_u32 s90, s90, s91
    buffer_load_ushort v128, v8, s[68:71], s90 offen offset:0
    buffer_load_ushort v132, v8, s[68:71], s90 offen offset:64
    s_mov_b32 exec_hi, -1
    s_lshl_b32 s90, s3, 1
    s_add_u32 s90, s90, s75
    s_lshl_b32 s91, s43, 7
    s_lshl_b32 s34, s90, 11
    s_add_u32 s34, s34, s91
    s_add_u32 s34, s34, 3145728
    s_lshl_b32 s38, s90, 10
    s_add_u32 s38, s38, s91
    s_add_u32 s38, s38, 3407872
    s_lshl_b32 s90, s3, 4
    s_lshl_b32 s91, s75, 2
    s_add_u32 s11, s91, s90
    s_lshl_b32 s90, s72, 2
    s_add_u32 s90, s90, s75
    s_mul_i32 s15, s90, 112
    s_lshl_b32 s91, s73, 3
    s_add_u32 s15, s15, s91
    s_lshl_b32 s15, s15, 10
    s_add_u32 s15, s15, 6815744
    s_lshr_b32 s90, s90, 1
    s_lshl_b32 s90, s90, 13
    s_add_u32 s90, s90, 3145728
    s_mul_i32 s91, s73, 592
    s_and_b32 s8, s91, 0xf800
    s_add_u32 s8, s8, s90
    s_add_u32 s91, s91, 296
    s_and_b32 s76, s91, 0xf800
    s_add_u32 s76, s76, s90
    s_add_u32 s76, s76, 1024
    s_lshr_b32 s91, 1032, s73
    s_and_b32 s91, s91, 1
    s_lshl_b32 s91, s91, 10
    s_add_u32 s8, s8, s91
    s_cmp_ge_u32 s73, 14
    s_cselect_b32 s76, 0x7000000, s76
    v_add_u32 v7, 114688, v2
    v_lshlrev_b32 v192, 7, v1
    s_lshl_b32 s93, s2, 2
    s_add_u32 s93, s93, s75
    s_mul_i32 s88, s93, 1664
    s_lshl_b32 s87, s93, 9
    v_and_b32 v8, 15, v1
    v_lshrrev_b32 v9, 4, v1
    v_bfe_u32 v10, v1, 1, 3
    v_xor_b32 v10, v9, v10
    v_lshlrev_b32 v8, 7, v8
    v_lshl_add_u32 v8, v10, 4, v8
    s_lshl_b32 s90, s75, 12
    v_add_u32 v136, s90, v8
    v_xor_b32 v137, 64, v136
    v_bfe_u32 v11, v1, 2, 2
    v_lshl_add_u32 v8, v9, 3, v11
    v_lshlrev_b32 v8, 8, v8
    v_lshl_add_u32 v8, v11, 6, v8
    v_and_b32 v10, 1, v9
    v_lshl_add_u32 v8, v10, 5, v8
    v_and_b32 v10, 1, v1
    v_lshl_add_u32 v8, v10, 4, v8
    v_bfe_u32 v10, v1, 1, 1
    v_lshl_add_u32 v8, v10, 3, v8
    v_add_u32 v138, 16384, v8
    v_xor_b32 v139, 32, v138
    v_xor_b32 v140, 64, v138
    v_xor_b32 v141, 96, v138
    v_xor_b32 v142, 128, v138
    v_xor_b32 v143, 160, v138
    v_xor_b32 v144, 192, v138
    v_xor_b32 v145, 224, v138
    v_bfe_u32 v12, v1, 4, 1
    v_lshlrev_b32 v12, 5, v12
    v_and_b32 v11, 3, v1
    v_lshl_add_u32 v12, v11, 3, v12
    v_bfe_u32 v11, v1, 2, 2
    v_lshrrev_b32 v10, 5, v1
    v_lshl_add_u32 v8, v10, 2, v11
    v_lshl_add_u32 v8, v8, 7, v12
    v_bfe_u32 v9, v1, 3, 1
    v_lshl_add_u32 v8, v9, 6, v8
    v_add_u32 v14, s14, v8
    v_xor_b32 v15, 64, v14
    v_add_u32 v16, 65536, v14
    v_add_u32 v17, 65536, v15
    v_lshlrev_b32 v8, 9, v10
    v_sub_u32 v22, v16, v8
    v_sub_u32 v23, v17, v8
    s_cmp_ge_u32 s73, 14
    s_nop 0
    s_cbranch_scc1 L_nof
    s_waitcnt lgkmcnt(0)
    s_add_u32 s78, s42, 0x9E3779B9
    s_mov_b32 s79, s78
    v_mov_b32 v4, s78
    s_barrier
    ds_read_b128 v[108:111], v136 offset:0
    ds_read_b128 v[112:115], v136 offset:2048
    ds_read_b64_tr_b16 v[88:89], v138 offset:0
    ds_read_b64_tr_b16 v[90:91], v138 offset:1024
    ds_read_b64_tr_b16 v[92:93], v139 offset:0
    ds_read_b64_tr_b16 v[94:95], v139 offset:1024
    ds_read_b64_tr_b16 v[96:97], v140 offset:0
    ds_read_b64_tr_b16 v[98:99], v140 offset:1024
    ds_read_b64_tr_b16 v[100:101], v141 offset:0
    ds_read_b64_tr_b16 v[102:103], v141 offset:1024
    ds_read_b64_tr_b16 v[104:105], v142 offset:0
    ds_read_b64_tr_b16 v[106:107], v142 offset:1024
    s_waitcnt lgkmcnt(8)
    v_mfma_f32_16x16x32_bf16 v[24:27], v[88:91], v[108:111], 0
    v_mfma_f32_16x16x32_bf16 v[28:31], v[88:91], v[112:115], 0
    ds_read_b64_tr_b16 v[88:89], v143 offset:0
    ds_read_b64_tr_b16 v[90:91], v143 offset:1024
    s_waitcnt lgkmcnt(8)
    v_mfma_f32_16x16x32_bf16 v[32:35], v[92:95], v[108:111], 0
    v_mfma_f32_16x16x32_bf16 v[36:39], v[92:95], v[112:115], 0
    ds_read_b64_tr_b16 v[92:93], v144 offset:0
    ds_read_b64_tr_b16 v[94:95], v144 offset:1024
    s_waitcnt lgkmcnt(8)
    v_mfma_f32_16x16x32_bf16 v[40:43], v[96:99], v[108:111], 0
    v_mfma_f32_16x16x32_bf16 v[44:47], v[96:99], v[112:115], 0
    ds_read_b64_tr_b16 v[96:97], v145 offset:0
    ds_read_b64_tr_b16 v[98:99], v145 offset:1024
    s_waitcnt lgkmcnt(8)
    v_mfma_f32_16x16x32_bf16 v[48:51], v[100:103], v[108:111], 0
    v_mfma_f32_16x16x32_bf16 v[52:55], v[100:103], v[112:115], 0
    ds_read_b128 v[116:119], v137 offset:0
    ds_read_b128 v[120:123], v137 offset:2048
    ds_read_b64_tr_b16 v[100:101], v138 offset:8192
    ds_read_b64_tr_b16 v[102:103], v138 offset:9216
    s_waitcnt lgkmcnt(10)
    v_mfma_f32_16x16x32_bf16 v[56:59], v[104:107], v[108:111], 0
    v_mfma_f32_16x16x32_bf16 v[60:63], v[104:107], v[112:115], 0
    ds_read_b64_tr_b16 v[104:105], v139 offset:8192
    ds_read_b64_tr_b16 v[106:107], v139 offset:9216
    s_waitcnt lgkmcnt(10)
    v_mfma_f32_16x16x32_bf16 v[64:67], v[88:91], v[108:111], 0
    v_mfma_f32_16x16x32_bf16 v[68:71], v[88:91], v[112:115], 0
    ds_read_b64_tr_b16 v[88:89], v140 offset:8192
    ds_read_b64_tr_b16 v[90:91], v140 offset:9216
    s_waitcnt lgkmcnt(10)
    v_mfma_f32_16x16x32_bf16 v[72:75], v[92:95], v[108:111], 0
    v_mfma_f32_16x16x32_bf16 v[76:79], v[92:95], v[112:115], 0
    ds_read_b64_tr_b16 v[92:93], v141 offset:8192
    ds_read_b64_tr_b16 v[94:95], v141 offset:9216
    s_waitcnt lgkmcnt(10)
    v_mfma_f32_16x16x32_bf16 v[80:83], v[96:99], v[108:111], 0
    v_mfma_f32_16x16x32_bf16 v[84:87], v[96:99], v[112:115], 0
    ds_read_b64_tr_b16 v[96:97], v142 offset:8192
    ds_read_b64_tr_b16 v[98:99], v142 offset:9216
    s_waitcnt lgkmcnt(8)
    v_mfma_f32_16x16x32_bf16 v[24:27], v[100:103], v[116:119], v[24:27]
    v_mfma_f32_16x16x32_bf16 v[28:31], v[100:103], v[120:123], v[28:31]
    ds_read_b64_tr_b16 v[100:101], v143 offset:8192
    ds_read_b64_tr_b16 v[102:103], v143 offset:9216
    s_waitcnt lgkmcnt(8)
    v_mfma_f32_16x16x32_bf16 v[32:35], v[104:107], v[116:119], v[32:35]
    v_mfma_f32_16x16x32_bf16 v[36:39], v[104:107], v[120:123], v[36:39]
    ds_read_b64_tr_b16 v[104:105], v144 offset:8192
    ds_read_b64_tr_b16 v[106:107], v144 offset:9216
    s_waitcnt lgkmcnt(8)
    v_mfma_f32_16x16x32_bf16 v[40:43], v[88:91], v[116:119], v[40:43]
    v_mfma_f32_16x16x32_bf16 v[44:47], v[88:91], v[120:123], v[44:47]
    ds_read_b64_tr_b16 v[88:89], v145 offset:8192
    ds_read_b64_tr_b16 v[90:91], v145 offset:9216
    s_waitcnt lgkmcnt(8)
    v_mfma_f32_16x16x32_bf16 v[48:51], v[92:95], v[116:119], v[48:51]
    v_mfma_f32_16x16x32_bf16 v[52:55], v[92:95], v[120:123], v[52:55]
    s_barrier
    ds_read_b128 v[108:111], v136 offset:32768
    ds_read_b128 v[112:115], v136 offset:34816
    ds_read_b64_tr_b16 v[92:93], v138 offset:32768
    ds_read_b64_tr_b16 v[94:95], v138 offset:33792
    s_waitcnt lgkmcnt(10)
    v_mfma_f32_16x16x32_bf16 v[56:59], v[96:99], v[116:119], v[56:59]
    v_mfma_f32_16x16x32_bf16 v[60:63], v[96:99], v[120:123], v[60:63]
    ds_read_b64_tr_b16 v[96:97], v139 offset:32768
    ds_read_b64_tr_b16 v[98:99], v139 offset:33792
    s_waitcnt lgkmcnt(10)
    v_mfma_f32_16x16x32_bf16 v[64:67], v[100:103], v[116:119], v[64:67]
    v_mfma_f32_16x16x32_bf16 v[68:71], v[100:103], v[120:123], v[68:71]
    ds_read_b64_tr_b16 v[100:101], v140 offset:32768
    ds_read_b64_tr_b16 v[102:103], v140 offset:33792
    s_waitcnt lgkmcnt(10)
    v_mfma_f32_16x16x32_bf16 v[72:75], v[104:107], v[116:119], v[72:75]
    v_mfma_f32_16x16x32_bf16 v[76:79], v[104:107], v[120:123], v[76:79]
    ds_read_b64_tr_b16 v[104:105], v141 offset:32768
    ds_read_b64_tr_b16 v[106:107], v141 offset:33792
    s_waitcnt lgkmcnt(10)
    v_mfma_f32_16x16x32_bf16 v[80:83], v[88:91], v[116:119], v[80:83]
    v_mfma_f32_16x16x32_bf16 v[84:87], v[88:91], v[120:123], v[84:87]
    ds_read_b64_tr_b16 v[88:89], v142 offset:32768
    ds_read_b64_tr_b16 v[90:91], v142 offset:33792
    s_waitcnt lgkmcnt(8)
    v_mfma_f32_16x16x32_bf16 v[24:27], v[92:95], v[108:111], v[24:27]
    v_mfma_f32_16x16x32_bf16 v[28:31], v[92:95], v[112:115], v[28:31]
    ds_read_b64_tr_b16 v[92:93], v143 offset:32768
    ds_read_b64_tr_b16 v[94:95], v143 offset:33792
    s_waitcnt lgkmcnt(8)
    v_mfma_f32_16x16x32_bf16 v[32:35], v[96:99], v[108:111], v[32:35]
    v_mfma_f32_16x16x32_bf16 v[36:39], v[96:99], v[112:115], v[36:39]
    ds_read_b64_tr_b16 v[96:97], v144 offset:32768
    ds_read_b64_tr_b16 v[98:99], v144 offset:33792
    s_waitcnt lgkmcnt(8)
    v_mfma_f32_16x16x32_bf16 v[40:43], v[100:103], v[108:111], v[40:43]
    v_mfma_f32_16x16x32_bf16 v[44:47], v[100:103], v[112:115], v[44:47]
    ds_read_b64_tr_b16 v[100:101], v145 offset:32768
    ds_read_b64_tr_b16 v[102:103], v145 offset:33792
    s_waitcnt lgkmcnt(8)
    v_mfma_f32_16x16x32_bf16 v[48:51], v[104:107], v[108:111], v[48:51]
    v_mfma_f32_16x16x32_bf16 v[52:55], v[104:107], v[112:115], v[52:55]
    ds_read_b128 v[116:119], v137 offset:32768
    ds_read_b128 v[120:123], v137 offset:34816
    ds_read_b64_tr_b16 v[104:105], v138 offset:40960
    ds_read_b64_tr_b16 v[106:107], v138 offset:41984
    s_waitcnt lgkmcnt(10)
    v_mfma_f32_16x16x32_bf16 v[56:59], v[88:91], v[108:111], v[56:59]
    v_mfma_f32_16x16x32_bf16 v[60:63], v[88:91], v[112:115], v[60:63]
    ds_read_b64_tr_b16 v[88:89], v139 offset:40960
    ds_read_b64_tr_b16 v[90:91], v139 offset:41984
    s_waitcnt lgkmcnt(10)
    v_mfma_f32_16x16x32_bf16 v[64:67], v[92:95], v[108:111], v[64:67]
    v_mfma_f32_16x16x32_bf16 v[68:71], v[92:95], v[112:115], v[68:71]
    ds_read_b64_tr_b16 v[92:93], v140 offset:40960
    ds_read_b64_tr_b16 v[94:95], v140 offset:41984
    s_waitcnt lgkmcnt(10)
    v_mfma_f32_16x16x32_bf16 v[72:75], v[96:99], v[108:111], v[72:75]
    v_mfma_f32_16x16x32_bf16 v[76:79], v[96:99], v[112:115], v[76:79]
    ds_read_b64_tr_b16 v[96:97], v141 offset:40960
    ds_read_b64_tr_b16 v[98:99], v141 offset:41984
    s_waitcnt lgkmcnt(10)
    v_mfma_f32_16x16x32_bf16 v[80:83], v[100:103], v[108:111], v[80:83]
    v_mfma_f32_16x16x32_bf16 v[84:87], v[100:103], v[112:115], v[84:87]
    ds_read_b64_tr_b16 v[100:101], v142 offset:40960
    ds_read_b64_tr_b16 v[102:103], v142 offset:41984
    s_waitcnt lgkmcnt(8)
    v_mfma_f32_16x16x32_bf16 v[24:27], v[104:107], v[116:119], v[24:27]
    v_mfma_f32_16x16x32_bf16 v[28:31], v[104:107], v[120:123], v[28:31]
    ds_read_b64_tr_b16 v[104:105], v143 offset:40960
    ds_read_b64_tr_b16 v[106:107], v143 offset:41984
    s_waitcnt lgkmcnt(8)
    v_mfma_f32_16x16x32_bf16 v[32:35], v[88:91], v[116:119], v[32:35]
    v_mfma_f32_16x16x32_bf16 v[36:39], v[88:91], v[120:123], v[36:39]
    ds_read_b64_tr_b16 v[88:89], v144 offset:40960
    ds_read_b64_tr_b16 v[90:91], v144 offset:41984
    s_waitcnt lgkmcnt(8)
    v_mfma_f32_16x16x32_bf16 v[40:43], v[92:95], v[116:119], v[40:43]
    v_mfma_f32_16x16x32_bf16 v[44:47], v[92:95], v[120:123], v[44:47]
    ds_read_b64_tr_b16 v[92:93], v145 offset:40960
    ds_read_b64_tr_b16 v[94:95], v145 offset:41984
    s_waitcnt lgkmcnt(8)
    v_mfma_f32_16x16x32_bf16 v[48:51], v[96:99], v[116:119], v[48:51]
    v_mfma_f32_16x16x32_bf16 v[52:55], v[96:99], v[120:123], v[52:55]
    v_add_u32 v136, 65536, v136
    v_add_u32 v137, 65536, v137
    v_add_u32 v138, 65536, v138
    v_add_u32 v139, 65536, v139
    v_add_u32 v140, 65536, v140
    v_add_u32 v141, 65536, v141
    v_add_u32 v142, 65536, v142
    v_add_u32 v143, 65536, v143
    v_add_u32 v144, 65536, v144
    v_add_u32 v145, 65536, v145
    s_barrier
    ds_read_b128 v[108:111], v136 offset:0
    ds_read_b128 v[112:115], v136 offset:2048
    ds_read_b64_tr_b16 v[96:97], v138 offset:0
    ds_read_b64_tr_b16 v[98:99], v138 offset:1024
    s_waitcnt lgkmcnt(10)
    v_mfma_f32_16x16x32_bf16 v[56:59], v[100:103], v[116:119], v[56:59]
    v_mfma_f32_16x16x32_bf16 v[60:63], v[100:103], v[120:123], v[60:63]
    ds_read_b64_tr_b16 v[100:101], v139 offset:0
    ds_read_b64_tr_b16 v[102:103], v139 offset:1024
    s_waitcnt lgkmcnt(10)
    v_mfma_f32_16x16x32_bf16 v[64:67], v[104:107], v[116:119], v[64:67]
    v_mfma_f32_16x16x32_bf16 v[68:71], v[104:107], v[120:123], v[68:71]
    ds_read_b64_tr_b16 v[104:105], v140 offset:0
    ds_read_b64_tr_b16 v[106:107], v140 offset:1024
    s_waitcnt lgkmcnt(10)
    v_mfma_f32_16x16x32_bf16 v[72:75], v[88:91], v[116:119], v[72:75]
    v_mfma_f32_16x16x32_bf16 v[76:79], v[88:91], v[120:123], v[76:79]
    ds_read_b64_tr_b16 v[88:89], v141 offset:0
    ds_read_b64_tr_b16 v[90:91], v141 offset:1024
    s_waitcnt lgkmcnt(10)
    v_mfma_f32_16x16x32_bf16 v[80:83], v[92:95], v[116:119], v[80:83]
    v_mfma_f32_16x16x32_bf16 v[84:87], v[92:95], v[120:123], v[84:87]
    ds_read_b64_tr_b16 v[92:93], v142 offset:0
    ds_read_b64_tr_b16 v[94:95], v142 offset:1024
    s_waitcnt lgkmcnt(8)
    v_mfma_f32_16x16x32_bf16 v[24:27], v[96:99], v[108:111], v[24:27]
    v_mfma_f32_16x16x32_bf16 v[28:31], v[96:99], v[112:115], v[28:31]
    ds_read_b64_tr_b16 v[96:97], v143 offset:0
    ds_read_b64_tr_b16 v[98:99], v143 offset:1024
    s_waitcnt lgkmcnt(8)
    v_mfma_f32_16x16x32_bf16 v[32:35], v[100:103], v[108:111], v[32:35]
    v_mfma_f32_16x16x32_bf16 v[36:39], v[100:103], v[112:115], v[36:39]
    ds_read_b64_tr_b16 v[100:101], v144 offset:0
    ds_read_b64_tr_b16 v[102:103], v144 offset:1024
    s_waitcnt lgkmcnt(8)
    v_mfma_f32_16x16x32_bf16 v[40:43], v[104:107], v[108:111], v[40:43]
    v_mfma_f32_16x16x32_bf16 v[44:47], v[104:107], v[112:115], v[44:47]
    ds_read_b64_tr_b16 v[104:105], v145 offset:0
    ds_read_b64_tr_b16 v[106:107], v145 offset:1024
    s_waitcnt lgkmcnt(8)
    v_mfma_f32_16x16x32_bf16 v[48:51], v[88:91], v[108:111], v[48:51]
    v_mfma_f32_16x16x32_bf16 v[52:55], v[88:91], v[112:115], v[52:55]
    ds_read_b128 v[116:119], v137 offset:0
    ds_read_b128 v[120:123], v137 offset:2048
    ds_read_b64_tr_b16 v[88:89], v138 offset:8192
    ds_read_b64_tr_b16 v[90:91], v138 offset:9216
    s_waitcnt lgkmcnt(10)
    v_mfma_f32_16x16x32_bf16 v[56:59], v[92:95], v[108:111], v[56:59]
    v_mfma_f32_16x16x32_bf16 v[60:63], v[92:95], v[112:115], v[60:63]
    ds_read_b64_tr_b16 v[92:93], v139 offset:8192
    ds_read_b64_tr_b16 v[94:95], v139 offset:9216
    s_waitcnt lgkmcnt(10)
    v_mfma_f32_16x16x32_bf16 v[64:67], v[96:99], v[108:111], v[64:67]
    v_mfma_f32_16x16x32_bf16 v[68:71], v[96:99], v[112:115], v[68:71]
    ds_read_b64_tr_b16 v[96:97], v140 offset:8192
    ds_read_b64_tr_b16 v[98:99], v140 offset:9216
    s_waitcnt lgkmcnt(10)
    v_mfma_f32_16x16x32_bf16 v[72:75], v[100:103], v[108:111], v[72:75]
    v_mfma_f32_16x16x32_bf16 v[76:79], v[100:103], v[112:115], v[76:79]
    ds_read_b64_tr_b16 v[100:101], v141 offset:8192
    ds_read_b64_tr_b16 v[102:103], v141 offset:9216
    s_waitcnt lgkmcnt(10)
    v_mfma_f32_16x16x32_bf16 v[80:83], v[104:107], v[108:111], v[80:83]
    v_mfma_f32_16x16x32_bf16 v[84:87], v[104:107], v[112:115], v[84:87]
    ds_read_b64_tr_b16 v[104:105], v142 offset:8192
    ds_read_b64_tr_b16 v[106:107], v142 offset:9216
    s_waitcnt lgkmcnt(8)
    v_mfma_f32_16x16x32_bf16 v[24:27], v[88:91], v[116:119], v[24:27]
    v_mfma_f32_16x16x32_bf16 v[28:31], v[88:91], v[120:123], v[28:31]
    ds_read_b64_tr_b16 v[88:89], v143 offset:8192
    ds_read_b64_tr_b16 v[90:91], v143 offset:9216
    s_waitcnt lgkmcnt(8)
    v_mfma_f32_16x16x32_bf16 v[32:35], v[92:95], v[116:119], v[32:35]
    v_mfma_f32_16x16x32_bf16 v[36:39], v[92:95], v[120:123], v[36:39]
    ds_read_b64_tr_b16 v[92:93], v144 offset:8192
    ds_read_b64_tr_b16 v[94:95], v144 offset:9216
    s_waitcnt lgkmcnt(8)
    v_mfma_f32_16x16x32_bf16 v[40:43], v[96:99], v[116:119], v[40:43]
    v_mfma_f32_16x16x32_bf16 v[44:47], v[96:99], v[120:123], v[44:47]
    ds_read_b64_tr_b16 v[96:97], v145 offset:8192
    ds_read_b64_tr_b16 v[98:99], v145 offset:9216
    s_waitcnt lgkmcnt(8)
    v_mfma_f32_16x16x32_bf16 v[48:51], v[100:103], v[116:119], v[48:51]
    v_mfma_f32_16x16x32_bf16 v[52:55], v[100:103], v[120:123], v[52:55]
    s_waitcnt vmcnt(0)
    s_barrier
    ds_read_b128 v[108:111], v136 offset:32768
    ds_read_b128 v[112:115], v136 offset:34816
    ds_read_b64_tr_b16 v[100:101], v138 offset:32768
    ds_read_b64_tr_b16 v[102:103], v138 offset:33792
    s_waitcnt lgkmcnt(10)
    v_mfma_f32_16x16x32_bf16 v[56:59], v[104:107], v[116:119], v[56:59]
    v_mfma_f32_16x16x32_bf16 v[60:63], v[104:107], v[120:123], v[60:63]
    ds_read_b64_tr_b16 v[104:105], v139 offset:32768
    ds_read_b64_tr_b16 v[106:107], v139 offset:33792
    s_waitcnt lgkmcnt(10)
    v_mfma_f32_16x16x32_bf16 v[64:67], v[88:91], v[116:119], v[64:67]
    v_mfma_f32_16x16x32_bf16 v[68:71], v[88:91], v[120:123], v[68:71]
    ds_read_b64_tr_b16 v[88:89], v140 offset:32768
    ds_read_b64_tr_b16 v[90:91], v140 offset:33792
    s_waitcnt lgkmcnt(10)
    v_mfma_f32_16x16x32_bf16 v[72:75], v[92:95], v[116:119], v[72:75]
    v_mfma_f32_16x16x32_bf16 v[76:79], v[92:95], v[120:123], v[76:79]
    ds_read_b64_tr_b16 v[92:93], v141 offset:32768
    ds_read_b64_tr_b16 v[94:95], v141 offset:33792
    s_waitcnt lgkmcnt(10)
    v_mfma_f32_16x16x32_bf16 v[80:83], v[96:99], v[116:119], v[80:83]
    v_mfma_f32_16x16x32_bf16 v[84:87], v[96:99], v[120:123], v[84:87]
    ds_read_b64_tr_b16 v[96:97], v142 offset:32768
    ds_read_b64_tr_b16 v[98:99], v142 offset:33792
    s_waitcnt lgkmcnt(8)
    v_mfma_f32_16x16x32_bf16 v[24:27], v[100:103], v[108:111], v[24:27]
    v_mfma_f32_16x16x32_bf16 v[28:31], v[100:103], v[112:115], v[28:31]
    ds_read_b64_tr_b16 v[100:101], v143 offset:32768
    ds_read_b64_tr_b16 v[102:103], v143 offset:33792
    s_waitcnt lgkmcnt(8)
    v_mfma_f32_16x16x32_bf16 v[32:35], v[104:107], v[108:111], v[32:35]
    v_mfma_f32_16x16x32_bf16 v[36:39], v[104:107], v[112:115], v[36:39]
    ds_read_b64_tr_b16 v[104:105], v144 offset:32768
    ds_read_b64_tr_b16 v[106:107], v144 offset:33792
    s_waitcnt lgkmcnt(8)
    v_mfma_f32_16x16x32_bf16 v[40:43], v[88:91], v[108:111], v[40:43]
    v_mfma_f32_16x16x32_bf16 v[44:47], v[88:91], v[112:115], v[44:47]
    ds_read_b64_tr_b16 v[88:89], v145 offset:32768
    ds_read_b64_tr_b16 v[90:91], v145 offset:33792
    s_waitcnt lgkmcnt(8)
    v_mfma_f32_16x16x32_bf16 v[48:51], v[92:95], v[108:111], v[48:51]
    v_mfma_f32_16x16x32_bf16 v[52:55], v[92:95], v[112:115], v[52:55]
    ds_read_b128 v[116:119], v137 offset:32768
    ds_read_b128 v[120:123], v137 offset:34816
    ds_read_b64_tr_b16 v[92:93], v138 offset:40960
    ds_read_b64_tr_b16 v[94:95], v138 offset:41984
    s_waitcnt lgkmcnt(10)
    v_mfma_f32_16x16x32_bf16 v[56:59], v[96:99], v[108:111], v[56:59]
    v_mfma_f32_16x16x32_bf16 v[60:63], v[96:99], v[112:115], v[60:63]
    v_mfma_f32_16x16x32_bf16 v[56:59], v[240:243], v[124:127], v[56:59]
    v_mfma_f32_16x16x32_bf16 v[60:63], v[240:243], v[124:127], v[60:63]
    ds_read_b64_tr_b16 v[96:97], v139 offset:40960
    ds_read_b64_tr_b16 v[98:99], v139 offset:41984
    s_waitcnt lgkmcnt(10)
    v_mfma_f32_16x16x32_bf16 v[64:67], v[100:103], v[108:111], v[64:67]
    v_mfma_f32_16x16x32_bf16 v[68:71], v[100:103], v[112:115], v[68:71]
    v_mfma_f32_16x16x32_bf16 v[64:67], v[244:247], v[124:127], v[64:67]
    v_mfma_f32_16x16x32_bf16 v[68:71], v[244:247], v[124:127], v[68:71]
    ds_read_b64_tr_b16 v[100:101], v140 offset:40960
    ds_read_b64_tr_b16 v[102:103], v140 offset:41984
    s_waitcnt lgkmcnt(10)
    v_mfma_f32_16x16x32_bf16 v[72:75], v[104:107], v[108:111], v[72:75]
    v_mfma_f32_16x16x32_bf16 v[76:79], v[104:107], v[112:115], v[76:79]
    v_mfma_f32_16x16x32_bf16 v[72:75], v[248:251], v[124:127], v[72:75]
    v_mfma_f32_16x16x32_bf16 v[76:79], v[248:251], v[124:127], v[76:79]
    ds_read_b64_tr_b16 v[104:105], v141 offset:40960
    ds_read_b64_tr_b16 v[106:107], v141 offset:41984
    s_waitcnt lgkmcnt(10)
    v_mfma_f32_16x16x32_bf16 v[80:83], v[88:91], v[108:111], v[80:83]
    v_mfma_f32_16x16x32_bf16 v[84:87], v[88:91], v[112:115], v[84:87]
    v_mfma_f32_16x16x32_bf16 v[80:83], v[252:255], v[124:127], v[80:83]
    v_mfma_f32_16x16x32_bf16 v[84:87], v[252:255], v[124:127], v[84:87]
    ds_read_b64_tr_b16 v[88:89], v142 offset:40960
    ds_read_b64_tr_b16 v[90:91], v142 offset:41984
    s_waitcnt lgkmcnt(8)
    v_mfma_f32_16x16x32_bf16 v[24:27], v[92:95], v[116:119], v[24:27]
    v_mfma_f32_16x16x32_bf16 v[28:31], v[92:95], v[120:123], v[28:31]
    v_mfma_f32_16x16x32_bf16 v[24:27], v[224:227], v[124:127], v[24:27]
    v_mfma_f32_16x16x32_bf16 v[28:31], v[224:227], v[124:127], v[28:31]
    ds_read_b64_tr_b16 v[92:93], v143 offset:40960
    ds_read_b64_tr_b16 v[94:95], v143 offset:41984
    s_waitcnt lgkmcnt(8)
    v_mfma_f32_16x16x32_bf16 v[32:35], v[96:99], v[116:119], v[32:35]
    v_mfma_f32_16x16x32_bf16 v[36:39], v[96:99], v[120:123], v[36:39]
    v_mfma_f32_16x16x32_bf16 v[32:35], v[228:231], v[124:127], v[32:35]
    v_mfma_f32_16x16x32_bf16 v[36:39], v[228:231], v[124:127], v[36:39]
    ds_read_b64_tr_b16 v[96:97], v144 offset:40960
    ds_read_b64_tr_b16 v[98:99], v144 offset:41984
    s_waitcnt lgkmcnt(8)
    v_mfma_f32_16x16x32_bf16 v[40:43], v[100:103], v[116:119], v[40:43]
    v_mfma_f32_16x16x32_bf16 v[44:47], v[100:103], v[120:123], v[44:47]
    v_mfma_f32_16x16x32_bf16 v[40:43], v[232:235], v[124:127], v[40:43]
    v_mfma_f32_16x16x32_bf16 v[44:47], v[232:235], v[124:127], v[44:47]
    ds_read_b64_tr_b16 v[100:101], v145 offset:40960
    ds_read_b64_tr_b16 v[102:103], v145 offset:41984
    s_waitcnt lgkmcnt(8)
    v_mfma_f32_16x16x32_bf16 v[48:51], v[104:107], v[116:119], v[48:51]
    v_mfma_f32_16x16x32_bf16 v[52:55], v[104:107], v[120:123], v[52:55]
    v_mfma_f32_16x16x32_bf16 v[48:51], v[236:239], v[124:127], v[48:51]
    v_mfma_f32_16x16x32_bf16 v[52:55], v[236:239], v[124:127], v[52:55]
    v_subrev_u32 v136, 65536, v136
    v_subrev_u32 v137, 65536, v137
    v_subrev_u32 v138, 65536, v138
    v_subrev_u32 v139, 65536, v139
    v_subrev_u32 v140, 65536, v140
    v_subrev_u32 v141, 65536, v141
    v_subrev_u32 v142, 65536, v142
    v_subrev_u32 v143, 65536, v143
    v_subrev_u32 v144, 65536, v144
    v_subrev_u32 v145, 65536, v145
    s_barrier
    ds_read_b128 v[108:111], v136 offset:0
    ds_read_b128 v[112:115], v136 offset:2048
    ds_read_b64_tr_b16 v[104:105], v138 offset:0
    ds_read_b64_tr_b16 v[106:107], v138 offset:1024
    s_waitcnt lgkmcnt(10)
    v_mfma_f32_16x16x32_bf16 v[56:59], v[88:91], v[116:119], v[56:59]
    v_mfma_f32_16x16x32_bf16 v[60:63], v[88:91], v[120:123], v[60:63]
    ds_read_b64_tr_b16 v[88:89], v139 offset:0
    ds_read_b64_tr_b16 v[90:91], v139 offset:1024
    s_mov_b64 exec, 0x1fff
    buffer_load_dword v5, v192, s[52:55], s88 offen
    s_mov_b64 exec, 15
    buffer_load_dword v5, v192, s[56:59], s87 offen
    s_mov_b64 exec, -1
    s_waitcnt lgkmcnt(10)
    v_mfma_f32_16x16x32_bf16 v[64:67], v[92:95], v[116:119], v[64:67]
    v_mfma_f32_16x16x32_bf16 v[68:71], v[92:95], v[120:123], v[68:71]
    ds_read_b64_tr_b16 v[92:93], v140 offset:0
    ds_read_b64_tr_b16 v[94:95], v140 offset:1024
    s_waitcnt lgkmcnt(10)
    v_mfma_f32_16x16x32_bf16 v[72:75], v[96:99], v[116:119], v[72:75]
    v_mfma_f32_16x16x32_bf16 v[76:79], v[96:99], v[120:123], v[76:79]
    ds_read_b64_tr_b16 v[96:97], v141 offset:0
    ds_read_b64_tr_b16 v[98:99], v141 offset:1024
    s_waitcnt lgkmcnt(10)
    v_mfma_f32_16x16x32_bf16 v[80:83], v[100:103], v[116:119], v[80:83]
    v_mfma_f32_16x16x32_bf16 v[84:87], v[100:103], v[120:123], v[84:87]
    ds_read_b64_tr_b16 v[100:101], v142 offset:0
    ds_read_b64_tr_b16 v[102:103], v142 offset:1024
    s_waitcnt lgkmcnt(8)
    v_mfma_f32_16x16x32_bf16 v[24:27], v[104:107], v[108:111], v[24:27]
    v_mfma_f32_16x16x32_bf16 v[28:31], v[104:107], v[112:115], v[28:31]
    ds_read_b64_tr_b16 v[104:105], v143 offset:0
    ds_read_b64_tr_b16 v[106:107], v143 offset:1024
    s_waitcnt lgkmcnt(8)
    v_mfma_f32_16x16x32_bf16 v[32:35], v[88:91], v[108:111], v[32:35]
    v_mfma_f32_16x16x32_bf16 v[36:39], v[88:91], v[112:115], v[36:39]
    ds_read_b64_tr_b16 v[88:89], v144 offset:0
    ds_read_b64_tr_b16 v[90:91], v144 offset:1024
    s_waitcnt lgkmcnt(8)
    v_mfma_f32_16x16x32_bf16 v[40:43], v[92:95], v[108:111], v[40:43]
    v_mfma_f32_16x16x32_bf16 v[44:47], v[92:95], v[112:115], v[44:47]
    ds_read_b64_tr_b16 v[92:93], v145 offset:0
    ds_read_b64_tr_b16 v[94:95], v145 offset:1024
    s_waitcnt lgkmcnt(8)
    v_mfma_f32_16x16x32_bf16 v[48:51], v[96:99], v[108:111], v[48:51]
    v_mfma_f32_16x16x32_bf16 v[52:55], v[96:99], v[112:115], v[52:55]
    ds_read_b128 v[116:119], v137 offset:0
    ds_read_b128 v[120:123], v137 offset:2048
    ds_read_b64_tr_b16 v[96:97], v138 offset:8192
    ds_read_b64_tr_b16 v[98:99], v138 offset:9216
    s_waitcnt lgkmcnt(10)
    v_mfma_f32_16x16x32_bf16 v[56:59], v[100:103], v[108:111], v[56:59]
    v_mfma_f32_16x16x32_bf16 v[60:63], v[100:103], v[112:115], v[60:63]
    ds_read_b64_tr_b16 v[100:101], v139 offset:8192
    ds_read_b64_tr_b16 v[102:103], v139 offset:9216
    s_waitcnt lgkmcnt(10)
    v_mfma_f32_16x16x32_bf16 v[64:67], v[104:107], v[108:111], v[64:67]
    v_mfma_f32_16x16x32_bf16 v[68:71], v[104:107], v[112:115], v[68:71]
    ds_read_b64_tr_b16 v[104:105], v140 offset:8192
    ds_read_b64_tr_b16 v[106:107], v140 offset:9216
    s_waitcnt lgkmcnt(10)
    v_mfma_f32_16x16x32_bf16 v[72:75], v[88:91], v[108:111], v[72:75]
    v_mfma_f32_16x16x32_bf16 v[76:79], v[88:91], v[112:115], v[76:79]
    ds_read_b64_tr_b16 v[88:89], v141 offset:8192
    ds_read_b64_tr_b16 v[90:91], v141 offset:9216
    s_waitcnt lgkmcnt(10)
    v_mfma_f32_16x16x32_bf16 v[80:83], v[92:95], v[108:111], v[80:83]
    v_mfma_f32_16x16x32_bf16 v[84:87], v[92:95], v[112:115], v[84:87]
    ds_read_b64_tr_b16 v[92:93], v142 offset:8192
    ds_read_b64_tr_b16 v[94:95], v142 offset:9216
    s_waitcnt lgkmcnt(8)
    v_mfma_f32_16x16x32_bf16 v[24:27], v[96:99], v[116:119], v[24:27]
    v_mfma_f32_16x16x32_bf16 v[28:31], v[96:99], v[120:123], v[28:31]
    ds_read_b64_tr_b16 v[96:97], v143 offset:8192
    ds_read_b64_tr_b16 v[98:99], v143 offset:9216
    s_waitcnt lgkmcnt(8)
    v_mfma_f32_16x16x32_bf16 v[32:35], v[100:103], v[116:119], v[32:35]
    v_mfma_f32_16x16x32_bf16 v[36:39], v[100:103], v[120:123], v[36:39]
    ds_read_b64_tr_b16 v[100:101], v144 offset:8192
    ds_read_b64_tr_b16 v[102:103], v144 offset:9216
    s_waitcnt lgkmcnt(8)
    v_mfma_f32_16x16x32_bf16 v[40:43], v[104:107], v[116:119], v[40:43]
    v_mfma_f32_16x16x32_bf16 v[44:47], v[104:107], v[120:123], v[44:47]
    ds_read_b64_tr_b16 v[104:105], v145 offset:8192
    ds_read_b64_tr_b16 v[106:107], v145 offset:9216
    s_waitcnt lgkmcnt(8)
    v_mfma_f32_16x16x32_bf16 v[48:51], v[88:91], v[116:119], v[48:51]
    v_mfma_f32_16x16x32_bf16 v[52:55], v[88:91], v[120:123], v[52:55]
    s_barrier
    ds_read_b128 v[108:111], v136 offset:32768
    ds_read_b128 v[112:115], v136 offset:34816
    ds_read_b64_tr_b16 v[88:89], v138 offset:32768
    ds_read_b64_tr_b16 v[90:91], v138 offset:33792
    s_waitcnt lgkmcnt(10)
    v_mfma_f32_16x16x32_bf16 v[56:59], v[92:95], v[116:119], v[56:59]
    v_mfma_f32_16x16x32_bf16 v[60:63], v[92:95], v[120:123], v[60:63]
    ds_read_b64_tr_b16 v[92:93], v139 offset:32768
    ds_read_b64_tr_b16 v[94:95], v139 offset:33792
    s_waitcnt lgkmcnt(10)
    v_mfma_f32_16x16x32_bf16 v[64:67], v[96:99], v[116:119], v[64:67]
    v_mfma_f32_16x16x32_bf16 v[68:71], v[96:99], v[120:123], v[68:71]
    ds_read_b64_tr_b16 v[96:97], v140 offset:32768
    ds_read_b64_tr_b16 v[98:99], v140 offset:33792
    s_waitcnt lgkmcnt(10)
    v_mfma_f32_16x16x32_bf16 v[72:75], v[100:103], v[116:119], v[72:75]
    v_mfma_f32_16x16x32_bf16 v[76:79], v[100:103], v[120:123], v[76:79]
    ds_read_b64_tr_b16 v[100:101], v141 offset:32768
    ds_read_b64_tr_b16 v[102:103], v141 offset:33792
    s_waitcnt lgkmcnt(10)
    v_mfma_f32_16x16x32_bf16 v[80:83], v[104:107], v[116:119], v[80:83]
    v_mfma_f32_16x16x32_bf16 v[84:87], v[104:107], v[120:123], v[84:87]
    ds_read_b64_tr_b16 v[104:105], v142 offset:32768
    ds_read_b64_tr_b16 v[106:107], v142 offset:33792
    s_waitcnt lgkmcnt(8)
    v_mfma_f32_16x16x32_bf16 v[24:27], v[88:91], v[108:111], v[24:27]
    v_mfma_f32_16x16x32_bf16 v[28:31], v[88:91], v[112:115], v[28:31]
    ds_read_b64_tr_b16 v[88:89], v143 offset:32768
    ds_read_b64_tr_b16 v[90:91], v143 offset:33792
    s_waitcnt lgkmcnt(8)
    v_mfma_f32_16x16x32_bf16 v[32:35], v[92:95], v[108:111], v[32:35]
    v_mfma_f32_16x16x32_bf16 v[36:39], v[92:95], v[112:115], v[36:39]
    ds_read_b64_tr_b16 v[92:93], v144 offset:32768
    ds_read_b64_tr_b16 v[94:95], v144 offset:33792
    s_waitcnt lgkmcnt(8)
    v_mfma_f32_16x16x32_bf16 v[40:43], v[96:99], v[108:111], v[40:43]
    v_mfma_f32_16x16x32_bf16 v[44:47], v[96:99], v[112:115], v[44:47]
    ds_read_b64_tr_b16 v[96:97], v145 offset:32768
    ds_read_b64_tr_b16 v[98:99], v145 offset:33792
    s_waitcnt lgkmcnt(8)
    v_mfma_f32_16x16x32_bf16 v[48:51], v[100:103], v[108:111], v[48:51]
    v_mfma_f32_16x16x32_bf16 v[52:55], v[100:103], v[112:115], v[52:55]
    ds_read_b128 v[116:119], v137 offset:32768
    ds_read_b128 v[120:123], v137 offset:34816
    ds_read_b64_tr_b16 v[100:101], v138 offset:40960
    ds_read_b64_tr_b16 v[102:103], v138 offset:41984
    s_waitcnt lgkmcnt(10)
    v_mfma_f32_16x16x32_bf16 v[56:59], v[104:107], v[108:111], v[56:59]
    v_mfma_f32_16x16x32_bf16 v[60:63], v[104:107], v[112:115], v[60:63]
    ds_read_b64_tr_b16 v[104:105], v139 offset:40960
    ds_read_b64_tr_b16 v[106:107], v139 offset:41984
    s_waitcnt lgkmcnt(10)
    v_mfma_f32_16x16x32_bf16 v[64:67], v[88:91], v[108:111], v[64:67]
    v_mfma_f32_16x16x32_bf16 v[68:71], v[88:91], v[112:115], v[68:71]
    ds_read_b64_tr_b16 v[88:89], v140 offset:40960
    ds_read_b64_tr_b16 v[90:91], v140 offset:41984
    s_waitcnt lgkmcnt(10)
    v_mfma_f32_16x16x32_bf16 v[72:75], v[92:95], v[108:111], v[72:75]
    v_mfma_f32_16x16x32_bf16 v[76:79], v[92:95], v[112:115], v[76:79]
    ds_read_b64_tr_b16 v[92:93], v141 offset:40960
    ds_read_b64_tr_b16 v[94:95], v141 offset:41984
    s_waitcnt lgkmcnt(10)
    v_mfma_f32_16x16x32_bf16 v[80:83], v[96:99], v[108:111], v[80:83]
    v_mfma_f32_16x16x32_bf16 v[84:87], v[96:99], v[112:115], v[84:87]
    ds_read_b64_tr_b16 v[96:97], v142 offset:40960
    ds_read_b64_tr_b16 v[98:99], v142 offset:41984
    s_waitcnt lgkmcnt(8)
    v_mfma_f32_16x16x32_bf16 v[24:27], v[100:103], v[116:119], v[24:27]
    v_mfma_f32_16x16x32_bf16 v[28:31], v[100:103], v[120:123], v[28:31]
    ds_read_b64_tr_b16 v[100:101], v143 offset:40960
    ds_read_b64_tr_b16 v[102:103], v143 offset:41984
    ds_read_b32 v12, v6 offset:36
    s_waitcnt lgkmcnt(9)
    v_mfma_f32_16x16x32_bf16 v[32:35], v[104:107], v[116:119], v[32:35]
    v_mfma_f32_16x16x32_bf16 v[36:39], v[104:107], v[120:123], v[36:39]
    ds_read_b64_tr_b16 v[104:105], v144 offset:40960
    ds_read_b64_tr_b16 v[106:107], v144 offset:41984
    s_waitcnt lgkmcnt(9)
    v_mfma_f32_16x16x32_bf16 v[40:43], v[88:91], v[116:119], v[40:43]
    v_mfma_f32_16x16x32_bf16 v[44:47], v[88:91], v[120:123], v[44:47]
    ds_read_b64_tr_b16 v[88:89], v145 offset:40960
    ds_read_b64_tr_b16 v[90:91], v145 offset:41984
    s_waitcnt lgkmcnt(9)
    v_mfma_f32_16x16x32_bf16 v[48:51], v[92:95], v[116:119], v[48:51]
    v_mfma_f32_16x16x32_bf16 v[52:55], v[92:95], v[120:123], v[52:55]
    v_add_u32 v136, 65536, v136
    v_add_u32 v137, 65536, v137
    v_add_u32 v138, 65536, v138
    v_add_u32 v139, 65536, v139
    v_add_u32 v140, 65536, v140
    v_add_u32 v141, 65536, v141
    v_add_u32 v142, 65536, v142
    v_add_u32 v143, 65536, v143
    v_add_u32 v144, 65536, v144
    v_add_u32 v145, 65536, v145
    s_waitcnt lgkmcnt(4)
    v_cmp_ne_u32 vcc, 4, v12
    s_cbranch_vccz L_s621
    s_mov_b32 s100, 160000
    s_nop 2
L_aw22:
    ds_read_b32 v13, v6 offset:36
    s_waitcnt lgkmcnt(0)
    v_cmp_ne_u32 vcc, 4, v13
    s_nop 4
    s_cbranch_vccz L_awd23
    s_sub_u32 s100, s100, 1
    s_cbranch_scc0 L_aw22
L_awd23:
L_s621:
    ds_read_b128 v[108:111], v136 offset:0
    ds_read_b128 v[112:115], v136 offset:2048
    ds_read_b64_tr_b16 v[92:93], v138 offset:0
    ds_read_b64_tr_b16 v[94:95], v138 offset:1024
    s_waitcnt lgkmcnt(11)
    v_mfma_f32_16x16x32_bf16 v[56:59], v[96:99], v[116:119], v[56:59]
    v_mfma_f32_16x16x32_bf16 v[60:63], v[96:99], v[120:123], v[60:63]
    ds_read_b64_tr_b16 v[96:97], v139 offset:0
    ds_read_b64_tr_b16 v[98:99], v139 offset:1024
    s_waitcnt lgkmcnt(11)
    v_mfma_f32_16x16x32_bf16 v[64:67], v[100:103], v[116:119], v[64:67]
    v_mfma_f32_16x16x32_bf16 v[68:71], v[100:103], v[120:123], v[68:71]
    ds_read_b64_tr_b16 v[100:101], v140 offset:0
    ds_read_b64_tr_b16 v[102:103], v140 offset:1024
    s_waitcnt lgkmcnt(10)
    v_mfma_f32_16x16x32_bf16 v[72:75], v[104:107], v[116:119], v[72:75]
    v_mfma_f32_16x16x32_bf16 v[76:79], v[104:107], v[120:123], v[76:79]
    ds_read_b64_tr_b16 v[104:105], v141 offset:0
    ds_read_b64_tr_b16 v[106:107], v141 offset:1024
    s_waitcnt lgkmcnt(10)
    v_mfma_f32_16x16x32_bf16 v[80:83], v[88:91], v[116:119], v[80:83]
    v_mfma_f32_16x16x32_bf16 v[84:87], v[88:91], v[120:123], v[84:87]
    ds_read_b64_tr_b16 v[88:89], v142 offset:0
    ds_read_b64_tr_b16 v[90:91], v142 offset:1024
    s_waitcnt lgkmcnt(8)
    v_mfma_f32_16x16x32_bf16 v[24:27], v[92:95], v[108:111], v[24:27]
    v_mfma_f32_16x16x32_bf16 v[28:31], v[92:95], v[112:115], v[28:31]
    ds_read_b64_tr_b16 v[92:93], v143 offset:0
    ds_read_b64_tr_b16 v[94:95], v143 offset:1024
    s_waitcnt lgkmcnt(8)
    v_mfma_f32_16x16x32_bf16 v[32:35], v[96:99], v[108:111], v[32:35]
    v_mfma_f32_16x16x32_bf16 v[36:39], v[96:99], v[112:115], v[36:39]
    ds_read_b64_tr_b16 v[96:97], v144 offset:0
    ds_read_b64_tr_b16 v[98:99], v144 offset:1024
    s_waitcnt lgkmcnt(8)
    v_mfma_f32_16x16x32_bf16 v[40:43], v[100:103], v[108:111], v[40:43]
    v_mfma_f32_16x16x32_bf16 v[44:47], v[100:103], v[112:115], v[44:47]
    ds_read_b64_tr_b16 v[100:101], v145 offset:0
    ds_read_b64_tr_b16 v[102:103], v145 offset:1024
    s_waitcnt lgkmcnt(8)
    v_mfma_f32_16x16x32_bf16 v[48:51], v[104:107], v[108:111], v[48:51]
    v_mfma_f32_16x16x32_bf16 v[52:55], v[104:107], v[112:115], v[52:55]
    ds_read_b128 v[116:119], v137 offset:0
    ds_read_b128 v[120:123], v137 offset:2048
    ds_read_b64_tr_b16 v[104:105], v138 offset:8192
    ds_read_b64_tr_b16 v[106:107], v138 offset:9216
    s_waitcnt lgkmcnt(10)
    v_mfma_f32_16x16x32_bf16 v[56:59], v[88:91], v[108:111], v[56:59]
    v_mfma_f32_16x16x32_bf16 v[60:63], v[88:91], v[112:115], v[60:63]
    ds_read_b64_tr_b16 v[88:89], v139 offset:8192
    ds_read_b64_tr_b16 v[90:91], v139 offset:9216
    s_waitcnt lgkmcnt(10)
    v_mfma_f32_16x16x32_bf16 v[64:67], v[92:95], v[108:111], v[64:67]
    v_mfma_f32_16x16x32_bf16 v[68:71], v[92:95], v[112:115], v[68:71]
    ds_read_b64_tr_b16 v[92:93], v140 offset:8192
    ds_read_b64_tr_b16 v[94:95], v140 offset:9216
    s_waitcnt lgkmcnt(10)
    v_mfma_f32_16x16x32_bf16 v[72:75], v[96:99], v[108:111], v[72:75]
    v_mfma_f32_16x16x32_bf16 v[76:79], v[96:99], v[112:115], v[76:79]
    ds_read_b64_tr_b16 v[96:97], v141 offset:8192
    ds_read_b64_tr_b16 v[98:99], v141 offset:9216
    s_waitcnt lgkmcnt(10)
    v_mfma_f32_16x16x32_bf16 v[80:83], v[100:103], v[108:111], v[80:83]
    v_mfma_f32_16x16x32_bf16 v[84:87], v[100:103], v[112:115], v[84:87]
    ds_read_b64_tr_b16 v[100:101], v142 offset:8192
    ds_read_b64_tr_b16 v[102:103], v142 offset:9216
    s_waitcnt lgkmcnt(8)
    v_mfma_f32_16x16x32_bf16 v[24:27], v[104:107], v[116:119], v[24:27]
    v_mfma_f32_16x16x32_bf16 v[28:31], v[104:107], v[120:123], v[28:31]
    ds_read_b64_tr_b16 v[104:105], v143 offset:8192
    ds_read_b64_tr_b16 v[106:107], v143 offset:9216
    s_waitcnt lgkmcnt(8)
    v_mfma_f32_16x16x32_bf16 v[32:35], v[88:91], v[116:119], v[32:35]
    v_mfma_f32_16x16x32_bf16 v[36:39], v[88:91], v[120:123], v[36:39]
    ds_read_b64_tr_b16 v[88:89], v144 offset:8192
    ds_read_b64_tr_b16 v[90:91], v144 offset:9216
    s_waitcnt lgkmcnt(8)
    v_mfma_f32_16x16x32_bf16 v[40:43], v[92:95], v[116:119], v[40:43]
    v_mfma_f32_16x16x32_bf16 v[44:47], v[92:95], v[120:123], v[44:47]
    ds_read_b64_tr_b16 v[92:93], v145 offset:8192
    ds_read_b64_tr_b16 v[94:95], v145 offset:9216
    s_waitcnt lgkmcnt(8)
    v_mfma_f32_16x16x32_bf16 v[48:51], v[96:99], v[116:119], v[48:51]
    v_mfma_f32_16x16x32_bf16 v[52:55], v[96:99], v[120:123], v[52:55]
    v_mov_b32 v13, 1
    s_mov_b64 exec, 1
    ds_add_u32 v6, v13 offset:0
    s_mov_b64 exec, -1
    s_waitcnt lgkmcnt(7)
    v_mfma_f32_16x16x32_bf16 v[56:59], v[100:103], v[116:119], v[56:59]
    v_mfma_f32_16x16x32_bf16 v[60:63], v[100:103], v[120:123], v[60:63]
    s_waitcnt lgkmcnt(5)
    v_mfma_f32_16x16x32_bf16 v[64:67], v[104:107], v[116:119], v[64:67]
    v_mfma_f32_16x16x32_bf16 v[68:71], v[104:107], v[120:123], v[68:71]
    s_waitcnt lgkmcnt(3)
    v_mfma_f32_16x16x32_bf16 v[72:75], v[88:91], v[116:119], v[72:75]
    v_mfma_f32_16x16x32_bf16 v[76:79], v[88:91], v[120:123], v[76:79]
    s_waitcnt lgkmcnt(1)
    v_mfma_f32_16x16x32_bf16 v[80:83], v[92:95], v[116:119], v[80:83]
    v_mfma_f32_16x16x32_bf16 v[84:87], v[92:95], v[120:123], v[84:87]
    s_setprio 2
    v_mov_b32 v8, 0xc0135761
    v_mov_b32 v9, 1.0
    s_mov_b32 s4, 0xbdd2d3e8
    s_mov_b32 s5, 0xbdd2d3e8
    v_pk_mul_f32 v[152:153], v[24:25], v[24:25]
    v_pk_mul_f32 v[154:155], v[26:27], v[26:27]
    v_pk_mul_f32 v[156:157], v[28:29], v[28:29]
    v_pk_mul_f32 v[158:159], v[30:31], v[30:31]
    v_pk_fma_f32 v[152:153], v[152:153], s[4:5], v[8:9] op_sel_hi:[1,1,0]
    v_pk_fma_f32 v[154:155], v[154:155], s[4:5], v[8:9] op_sel_hi:[1,1,0]
    v_pk_fma_f32 v[156:157], v[156:157], s[4:5], v[8:9] op_sel_hi:[1,1,0]
    v_pk_fma_f32 v[158:159], v[158:159], s[4:5], v[8:9] op_sel_hi:[1,1,0]
    v_pk_mul_f32 v[152:153], v[24:25], v[152:153]
    v_pk_mul_f32 v[154:155], v[26:27], v[154:155]
    v_pk_mul_f32 v[156:157], v[28:29], v[156:157]
    v_pk_mul_f32 v[158:159], v[30:31], v[158:159]
    v_exp_f32 v152, v152
    v_exp_f32 v153, v153
    v_exp_f32 v154, v154
    v_exp_f32 v155, v155
    v_exp_f32 v156, v156
    v_exp_f32 v157, v157
    v_exp_f32 v158, v158
    v_exp_f32 v159, v159
    v_pk_add_f32 v[152:153], v[152:153], v[8:9] op_sel:[0,1] op_sel_hi:[1,1]
    v_pk_add_f32 v[154:155], v[154:155], v[8:9] op_sel:[0,1] op_sel_hi:[1,1]
    v_pk_add_f32 v[156:157], v[156:157], v[8:9] op_sel:[0,1] op_sel_hi:[1,1]
    v_pk_add_f32 v[158:159], v[158:159], v[8:9] op_sel:[0,1] op_sel_hi:[1,1]
    v_rcp_f32 v152, v152
    v_rcp_f32 v153, v153
    v_rcp_f32 v154, v154
    v_rcp_f32 v155, v155
    v_rcp_f32 v156, v156
    v_rcp_f32 v157, v157
    v_rcp_f32 v158, v158
    v_rcp_f32 v159, v159
    v_pk_mul_f32 v[152:153], v[24:25], v[152:153]
    v_pk_mul_f32 v[154:155], v[26:27], v[154:155]
    v_pk_mul_f32 v[156:157], v[28:29], v[156:157]
    v_pk_mul_f32 v[158:159], v[30:31], v[158:159]
    v_cvt_pk_bf16_f32 v200, v152, v153
    v_cvt_pk_bf16_f32 v202, v156, v157
    v_cvt_pk_bf16_f32 v201, v154, v155
    v_cvt_pk_bf16_f32 v203, v158, v159
    v_permlane16_swap_b32 v200, v202
    s_nop 0
    v_permlane16_swap_b32 v201, v203
    s_setprio 3
    buffer_store_dwordx4 v[200:203], v2, s[60:63], s15 offen offset:0 sc1
    s_setprio 2
    v_pk_mul_f32 v[160:161], v[32:33], v[32:33]
    v_pk_mul_f32 v[162:163], v[34:35], v[34:35]
    v_pk_mul_f32 v[164:165], v[36:37], v[36:37]
    v_pk_mul_f32 v[166:167], v[38:39], v[38:39]
    v_pk_fma_f32 v[160:161], v[160:161], s[4:5], v[8:9] op_sel_hi:[1,1,0]
    v_pk_fma_f32 v[162:163], v[162:163], s[4:5], v[8:9] op_sel_hi:[1,1,0]
    v_pk_fma_f32 v[164:165], v[164:165], s[4:5], v[8:9] op_sel_hi:[1,1,0]
    v_pk_fma_f32 v[166:167], v[166:167], s[4:5], v[8:9] op_sel_hi:[1,1,0]
    v_pk_mul_f32 v[160:161], v[32:33], v[160:161]
    v_pk_mul_f32 v[162:163], v[34:35], v[162:163]
    v_pk_mul_f32 v[164:165], v[36:37], v[164:165]
    v_pk_mul_f32 v[166:167], v[38:39], v[166:167]
    v_exp_f32 v160, v160
    v_exp_f32 v161, v161
    v_exp_f32 v162, v162
    v_exp_f32 v163, v163
    v_exp_f32 v164, v164
    v_exp_f32 v165, v165
    v_exp_f32 v166, v166
    v_exp_f32 v167, v167
    v_pk_add_f32 v[160:161], v[160:161], v[8:9] op_sel:[0,1] op_sel_hi:[1,1]
    v_pk_add_f32 v[162:163], v[162:163], v[8:9] op_sel:[0,1] op_sel_hi:[1,1]
    v_pk_add_f32 v[164:165], v[164:165], v[8:9] op_sel:[0,1] op_sel_hi:[1,1]
    v_pk_add_f32 v[166:167], v[166:167], v[8:9] op_sel:[0,1] op_sel_hi:[1,1]
    v_rcp_f32 v160, v160
    v_rcp_f32 v161, v161
    v_rcp_f32 v162, v162
    v_rcp_f32 v163, v163
    v_rcp_f32 v164, v164
    v_rcp_f32 v165, v165
    v_rcp_f32 v166, v166
    v_rcp_f32 v167, v167
    v_pk_mul_f32 v[160:161], v[32:33], v[160:161]
    v_pk_mul_f32 v[162:163], v[34:35], v[162:163]
    v_pk_mul_f32 v[164:165], v[36:37], v[164:165]
    v_pk_mul_f32 v[166:167], v[38:39], v[166:167]
    v_cvt_pk_bf16_f32 v204, v160, v161
    v_cvt_pk_bf16_f32 v206, v164, v165
    v_cvt_pk_bf16_f32 v205, v162, v163
    v_cvt_pk_bf16_f32 v207, v166, v167
    v_permlane16_swap_b32 v204, v206
    s_nop 0
    v_permlane16_swap_b32 v205, v207
    s_setprio 3
    buffer_store_dwordx4 v[204:207], v2, s[60:63], s15 offen offset:1024 sc1
    s_setprio 2
    v_mul_f32 v152, v40, v40
    v_mul_f32 v153, v41, v41
    v_mul_f32 v154, v42, v42
    v_mul_f32 v155, v43, v43
    v_mul_f32 v156, v44, v44
    v_mul_f32 v157, v45, v45
    v_mul_f32 v158, v46, v46
    v_mul_f32 v159, v47, v47
    v_fma_f32 v152, v152, s4, v8
    v_fma_f32 v153, v153, s4, v8
    v_fma_f32 v154, v154, s4, v8
    v_fma_f32 v155, v155, s4, v8
    v_fma_f32 v156, v156, s4, v8
    v_fma_f32 v157, v157, s4, v8
    v_fma_f32 v158, v158, s4, v8
    v_fma_f32 v159, v159, s4, v8
    v_mul_f32 v152, v40, v152
    v_mul_f32 v153, v41, v153
    v_mul_f32 v154, v42, v154
    v_mul_f32 v155, v43, v155
    v_mul_f32 v156, v44, v156
    v_mul_f32 v157, v45, v157
    v_mul_f32 v158, v46, v158
    v_mul_f32 v159, v47, v159
    v_exp_f32 v152, v152
    v_exp_f32 v153, v153
    v_exp_f32 v154, v154
    v_exp_f32 v155, v155
    v_exp_f32 v156, v156
    v_exp_f32 v157, v157
    v_exp_f32 v158, v158
    v_exp_f32 v159, v159
    v_add_f32 v152, 1.0, v152
    v_add_f32 v153, 1.0, v153
    v_add_f32 v154, 1.0, v154
    v_add_f32 v155, 1.0, v155
    v_add_f32 v156, 1.0, v156
    v_add_f32 v157, 1.0, v157
    v_add_f32 v158, 1.0, v158
    v_add_f32 v159, 1.0, v159
    v_rcp_f32 v152, v152
    v_rcp_f32 v153, v153
    v_rcp_f32 v154, v154
    v_rcp_f32 v155, v155
    v_rcp_f32 v156, v156
    v_rcp_f32 v157, v157
    v_rcp_f32 v158, v158
    v_rcp_f32 v159, v159
    v_mul_f32 v152, v40, v152
    v_mul_f32 v153, v41, v153
    v_mul_f32 v154, v42, v154
    v_mul_f32 v155, v43, v155
    v_mul_f32 v156, v44, v156
    v_mul_f32 v157, v45, v157
    v_mul_f32 v158, v46, v158
    v_mul_f32 v159, v47, v159
    v_cvt_pk_bf16_f32 v208, v152, v153
    v_cvt_pk_bf16_f32 v210, v156, v157
    v_cvt_pk_bf16_f32 v209, v154, v155
    v_cvt_pk_bf16_f32 v211, v158, v159
    v_permlane16_swap_b32 v208, v210
    s_nop 0
    v_permlane16_swap_b32 v209, v211
    s_setprio 3
    buffer_store_dwordx4 v[208:211], v2, s[60:63], s15 offen offset:2048 sc1
    s_setprio 2
    v_mul_f32 v160, v48, v48
    v_mul_f32 v161, v49, v49
    v_mul_f32 v162, v50, v50
    v_mul_f32 v163, v51, v51
    v_mul_f32 v164, v52, v52
    v_mul_f32 v165, v53, v53
    v_mul_f32 v166, v54, v54
    v_mul_f32 v167, v55, v55
    v_fma_f32 v160, v160, s4, v8
    v_fma_f32 v161, v161, s4, v8
    v_fma_f32 v162, v162, s4, v8
    v_fma_f32 v163, v163, s4, v8
    v_fma_f32 v164, v164, s4, v8
    v_fma_f32 v165, v165, s4, v8
    v_fma_f32 v166, v166, s4, v8
    v_fma_f32 v167, v167, s4, v8
    v_mul_f32 v160, v48, v160
    v_mul_f32 v161, v49, v161
    v_mul_f32 v162, v50, v162
    v_mul_f32 v163, v51, v163
    v_mul_f32 v164, v52, v164
    v_mul_f32 v165, v53, v165
    v_mul_f32 v166, v54, v166
    v_mul_f32 v167, v55, v167
    v_exp_f32 v160, v160
    v_exp_f32 v161, v161
    v_exp_f32 v162, v162
    v_exp_f32 v163, v163
    v_exp_f32 v164, v164
    v_exp_f32 v165, v165
    v_exp_f32 v166, v166
    v_exp_f32 v167, v167
    v_add_f32 v160, 1.0, v160
    v_add_f32 v161, 1.0, v161
    v_add_f32 v162, 1.0, v162
    v_add_f32 v163, 1.0, v163
    v_add_f32 v164, 1.0, v164
    v_add_f32 v165, 1.0, v165
    v_add_f32 v166, 1.0, v166
    v_add_f32 v167, 1.0, v167
    v_rcp_f32 v160, v160
    v_rcp_f32 v161, v161
    v_rcp_f32 v162, v162
    v_rcp_f32 v163, v163
    v_rcp_f32 v164, v164
    v_rcp_f32 v165, v165
    v_rcp_f32 v166, v166
    v_rcp_f32 v167, v167
    v_mul_f32 v160, v48, v160
    v_mul_f32 v161, v49, v161
    v_mul_f32 v162, v50, v162
    v_mul_f32 v163, v51, v163
    v_mul_f32 v164, v52, v164
    v_mul_f32 v165, v53, v165
    v_mul_f32 v166, v54, v166
    v_mul_f32 v167, v55, v167
    v_cvt_pk_bf16_f32 v212, v160, v161
    v_cvt_pk_bf16_f32 v214, v164, v165
    v_cvt_pk_bf16_f32 v213, v162, v163
    v_cvt_pk_bf16_f32 v215, v166, v167
    v_permlane16_swap_b32 v212, v214
    s_nop 0
    v_permlane16_swap_b32 v213, v215
    s_setprio 3
    buffer_store_dwordx4 v[212:215], v2, s[60:63], s15 offen offset:3072 sc1
    s_setprio 2
    v_mul_f32 v152, v56, v56
    v_mul_f32 v153, v57, v57
    v_mul_f32 v154, v58, v58
    v_mul_f32 v155, v59, v59
    v_mul_f32 v156, v60, v60
    v_mul_f32 v157, v61, v61
    v_mul_f32 v158, v62, v62
    v_mul_f32 v159, v63, v63
    v_fma_f32 v152, v152, s4, v8
    v_fma_f32 v153, v153, s4, v8
    v_fma_f32 v154, v154, s4, v8
    v_fma_f32 v155, v155, s4, v8
    v_fma_f32 v156, v156, s4, v8
    v_fma_f32 v157, v157, s4, v8
    v_fma_f32 v158, v158, s4, v8
    v_fma_f32 v159, v159, s4, v8
    v_mul_f32 v152, v56, v152
    v_mul_f32 v153, v57, v153
    v_mul_f32 v154, v58, v154
    v_mul_f32 v155, v59, v155
    v_mul_f32 v156, v60, v156
    v_mul_f32 v157, v61, v157
    v_mul_f32 v158, v62, v158
    v_mul_f32 v159, v63, v159
    v_exp_f32 v152, v152
    v_exp_f32 v153, v153
    v_exp_f32 v154, v154
    v_exp_f32 v155, v155
    v_exp_f32 v156, v156
    v_exp_f32 v157, v157
    v_exp_f32 v158, v158
    v_exp_f32 v159, v159
    v_add_f32 v152, 1.0, v152
    v_add_f32 v153, 1.0, v153
    v_add_f32 v154, 1.0, v154
    v_add_f32 v155, 1.0, v155
    v_add_f32 v156, 1.0, v156
    v_add_f32 v157, 1.0, v157
    v_add_f32 v158, 1.0, v158
    v_add_f32 v159, 1.0, v159
    v_rcp_f32 v152, v152
    v_rcp_f32 v153, v153
    v_rcp_f32 v154, v154
    v_rcp_f32 v155, v155
    v_rcp_f32 v156, v156
    v_rcp_f32 v157, v157
    v_rcp_f32 v158, v158
    v_rcp_f32 v159, v159
    v_mul_f32 v152, v56, v152
    v_mul_f32 v153, v57, v153
    v_mul_f32 v154, v58, v154
    v_mul_f32 v155, v59, v155
    v_mul_f32 v156, v60, v156
    v_mul_f32 v157, v61, v157
    v_mul_f32 v158, v62, v158
    v_mul_f32 v159, v63, v159
    v_cvt_pk_bf16_f32 v216, v152, v153
    v_cvt_pk_bf16_f32 v218, v156, v157
    v_cvt_pk_bf16_f32 v217, v154, v155
    v_cvt_pk_bf16_f32 v219, v158, v159
    v_permlane16_swap_b32 v216, v218
    s_nop 0
    v_permlane16_swap_b32 v217, v219
    s_setprio 3
    s_add_u32 s15, s15, 4096
    buffer_store_dwordx4 v[216:219], v2, s[60:63], s15 offen offset:0 sc1
    s_setprio 2
    v_mul_f32 v160, v64, v64
    v_mul_f32 v161, v65, v65
    v_mul_f32 v162, v66, v66
    v_mul_f32 v163, v67, v67
    v_mul_f32 v164, v68, v68
    v_mul_f32 v165, v69, v69
    v_mul_f32 v166, v70, v70
    v_mul_f32 v167, v71, v71
    v_fma_f32 v160, v160, s4, v8
    v_fma_f32 v161, v161, s4, v8
    v_fma_f32 v162, v162, s4, v8
    v_fma_f32 v163, v163, s4, v8
    v_fma_f32 v164, v164, s4, v8
    v_fma_f32 v165, v165, s4, v8
    v_fma_f32 v166, v166, s4, v8
    v_fma_f32 v167, v167, s4, v8
    v_mul_f32 v160, v64, v160
    v_mul_f32 v161, v65, v161
    v_mul_f32 v162, v66, v162
    v_mul_f32 v163, v67, v163
    v_mul_f32 v164, v68, v164
    v_mul_f32 v165, v69, v165
    v_mul_f32 v166, v70, v166
    v_mul_f32 v167, v71, v167
    v_exp_f32 v160, v160
    v_exp_f32 v161, v161
    v_exp_f32 v162, v162
    v_exp_f32 v163, v163
    v_exp_f32 v164, v164
    v_exp_f32 v165, v165
    v_exp_f32 v166, v166
    v_exp_f32 v167, v167
    v_add_f32 v160, 1.0, v160
    v_add_f32 v161, 1.0, v161
    v_add_f32 v162, 1.0, v162
    v_add_f32 v163, 1.0, v163
    v_add_f32 v164, 1.0, v164
    v_add_f32 v165, 1.0, v165
    v_add_f32 v166, 1.0, v166
    v_add_f32 v167, 1.0, v167
    v_rcp_f32 v160, v160
    v_rcp_f32 v161, v161
    v_rcp_f32 v162, v162
    v_rcp_f32 v163, v163
    v_rcp_f32 v164, v164
    v_rcp_f32 v165, v165
    v_rcp_f32 v166, v166
    v_rcp_f32 v167, v167
    v_mul_f32 v160, v64, v160
    v_mul_f32 v161, v65, v161
    v_mul_f32 v162, v66, v162
    v_mul_f32 v163, v67, v163
    v_mul_f32 v164, v68, v164
    v_mul_f32 v165, v69, v165
    v_mul_f32 v166, v70, v166
    v_mul_f32 v167, v71, v167
    v_cvt_pk_bf16_f32 v220, v160, v161
    v_cvt_pk_bf16_f32 v222, v164, v165
    v_cvt_pk_bf16_f32 v221, v162, v163
    v_cvt_pk_bf16_f32 v223, v166, v167
    v_permlane16_swap_b32 v220, v222
    s_nop 0
    v_permlane16_swap_b32 v221, v223
    s_setprio 3
    buffer_store_dwordx4 v[220:223], v2, s[60:63], s15 offen offset:1024 sc1
    s_setprio 2
    v_mul_f32 v152, v72, v72
    v_mul_f32 v153, v73, v73
    v_mul_f32 v154, v74, v74
    v_mul_f32 v155, v75, v75
    v_mul_f32 v156, v76, v76
    v_mul_f32 v157, v77, v77
    v_mul_f32 v158, v78, v78
    v_mul_f32 v159, v79, v79
    v_fma_f32 v152, v152, s4, v8
    v_fma_f32 v153, v153, s4, v8
    v_fma_f32 v154, v154, s4, v8
    v_fma_f32 v155, v155, s4, v8
    v_fma_f32 v156, v156, s4, v8
    v_fma_f32 v157, v157, s4, v8
    v_fma_f32 v158, v158, s4, v8
    v_fma_f32 v159, v159, s4, v8
    v_mul_f32 v152, v72, v152
    v_mul_f32 v153, v73, v153
    v_mul_f32 v154, v74, v154
    v_mul_f32 v155, v75, v155
    v_mul_f32 v156, v76, v156
    v_mul_f32 v157, v77, v157
    v_mul_f32 v158, v78, v158
    v_mul_f32 v159, v79, v159
    v_exp_f32 v152, v152
    v_exp_f32 v153, v153
    v_exp_f32 v154, v154
    v_exp_f32 v155, v155
    v_exp_f32 v156, v156
    v_exp_f32 v157, v157
    v_exp_f32 v158, v158
    v_exp_f32 v159, v159
    v_add_f32 v152, 1.0, v152
    v_add_f32 v153, 1.0, v153
    v_add_f32 v154, 1.0, v154
    v_add_f32 v155, 1.0, v155
    v_add_f32 v156, 1.0, v156
    v_add_f32 v157, 1.0, v157
    v_add_f32 v158, 1.0, v158
    v_add_f32 v159, 1.0, v159
    v_rcp_f32 v152, v152
    v_rcp_f32 v153, v153
    v_rcp_f32 v154, v154
    v_rcp_f32 v155, v155
    v_rcp_f32 v156, v156
    v_rcp_f32 v157, v157
    v_rcp_f32 v158, v158
    v_rcp_f32 v159, v159
    v_mul_f32 v152, v72, v152
    v_mul_f32 v153, v73, v153
    v_mul_f32 v154, v74, v154
    v_mul_f32 v155, v75, v155
    v_mul_f32 v156, v76, v156
    v_mul_f32 v157, v77, v157
    v_mul_f32 v158, v78, v158
    v_mul_f32 v159, v79, v159
    v_cvt_pk_bf16_f32 v224, v152, v153
    v_cvt_pk_bf16_f32 v226, v156, v157
    v_cvt_pk_bf16_f32 v225, v154, v155
    v_cvt_pk_bf16_f32 v227, v158, v159
    v_permlane16_swap_b32 v224, v226
    s_nop 0
    v_permlane16_swap_b32 v225, v227
    s_setprio 3
    buffer_store_dwordx4 v[224:227], v2, s[60:63], s15 offen offset:2048 sc1
    s_setprio 2
    v_mul_f32 v160, v80, v80
    v_mul_f32 v161, v81, v81
    v_mul_f32 v162, v82, v82
    v_mul_f32 v163, v83, v83
    v_mul_f32 v164, v84, v84
    v_mul_f32 v165, v85, v85
    v_mul_f32 v166, v86, v86
    v_mul_f32 v167, v87, v87
    v_fma_f32 v160, v160, s4, v8
    v_fma_f32 v161, v161, s4, v8
    v_fma_f32 v162, v162, s4, v8
    v_fma_f32 v163, v163, s4, v8
    v_fma_f32 v164, v164, s4, v8
    v_fma_f32 v165, v165, s4, v8
    v_fma_f32 v166, v166, s4, v8
    v_fma_f32 v167, v167, s4, v8
    v_mul_f32 v160, v80, v160
    v_mul_f32 v161, v81, v161
    v_mul_f32 v162, v82, v162
    v_mul_f32 v163, v83, v163
    v_mul_f32 v164, v84, v164
    v_mul_f32 v165, v85, v165
    v_mul_f32 v166, v86, v166
    v_mul_f32 v167, v87, v167
    v_exp_f32 v160, v160
    v_exp_f32 v161, v161
    v_exp_f32 v162, v162
    v_exp_f32 v163, v163
    v_exp_f32 v164, v164
    v_exp_f32 v165, v165
    v_exp_f32 v166, v166
    v_exp_f32 v167, v167
    v_add_f32 v160, 1.0, v160
    v_add_f32 v161, 1.0, v161
    v_add_f32 v162, 1.0, v162
    v_add_f32 v163, 1.0, v163
    v_add_f32 v164, 1.0, v164
    v_add_f32 v165, 1.0, v165
    v_add_f32 v166, 1.0, v166
    v_add_f32 v167, 1.0, v167
    v_rcp_f32 v160, v160
    v_rcp_f32 v161, v161
    v_rcp_f32 v162, v162
    v_rcp_f32 v163, v163
    v_rcp_f32 v164, v164
    v_rcp_f32 v165, v165
    v_rcp_f32 v166, v166
    v_rcp_f32 v167, v167
    v_mul_f32 v160, v80, v160
    v_mul_f32 v161, v81, v161
    v_mul_f32 v162, v82, v162
    v_mul_f32 v163, v83, v163
    v_mul_f32 v164, v84, v164
    v_mul_f32 v165, v85, v165
    v_mul_f32 v166, v86, v166
    v_mul_f32 v167, v87, v167
    v_cvt_pk_bf16_f32 v228, v160, v161
    v_cvt_pk_bf16_f32 v230, v164, v165
    v_cvt_pk_bf16_f32 v229, v162, v163
    v_cvt_pk_bf16_f32 v231, v166, v167
    v_permlane16_swap_b32 v228, v230
    s_nop 0
    v_permlane16_swap_b32 v229, v231
    s_setprio 3
    buffer_store_dwordx4 v[228:231], v2, s[60:63], s15 offen offset:3072 sc1
    s_mov_b32 s100, 160000
    s_nop 0
L_aw24:
    ds_read_b32 v13, v6 offset:4
    s_waitcnt lgkmcnt(0)
    v_cmp_ne_u32 vcc, 4, v13
    s_nop 4
    s_cbranch_vccz L_awd25
    s_sub_u32 s100, s100, 1
    s_cbranch_scc0 L_aw24
L_awd25:
    s_waitcnt vmcnt(4)
    v_mov_b32 v13, 1
    v_lshlrev_b32 v5, 7, v1
    s_mov_b64 exec, 127
    buffer_atomic_add v13, v5, s[60:63], s8 offen
    s_mov_b64 exec, -1
    s_cmp_eq_u32 s101, 1
    s_cbranch_scc1 L_p2
    s_waitcnt vmcnt(0)
    v_mov_b32 v13, 1
    v_lshlrev_b32 v5, 7, v1
    s_mov_b64 exec, 127
    buffer_atomic_add v13, v5, s[60:63], s76 offen
    s_mov_b64 exec, -1
    s_branch L_fin
L_nof:
    s_mov_b64 exec, 0x1fff
    buffer_load_dword v5, v192, s[52:55], s88 offen
    s_mov_b64 exec, 15
    buffer_load_dword v5, v192, s[56:59], s87 offen
    s_mov_b64 exec, -1
    s_mov_b32 s100, 160000
L_aw26:
    ds_read_b32 v13, v6 offset:4
    s_waitcnt lgkmcnt(0)
    v_cmp_ne_u32 vcc, 4, v13
    s_nop 4
    s_cbranch_vccz L_awd27
    s_sleep 2
    s_sub_u32 s100, s100, 1
    s_cbranch_scc0 L_aw26
L_awd27:
    s_waitcnt lgkmcnt(0)
    s_add_u32 s78, s42, 0x9E3779B9
    s_mov_b32 s79, s78
    v_mov_b32 v4, s78
    s_waitcnt vmcnt(0)
    s_nop 0
L_p2:
    v_mfma_f32_32x32x16_bf16 v[24:39], v[128:131], v[124:127], 0
    v_mfma_f32_32x32x16_bf16 v[40:55], v[132:135], v[124:127], 0
    v_mfma_f32_32x32x16_bf16 v[56:71], v[128:131], v[124:127], 0
    v_mfma_f32_32x32x16_bf16 v[72:87], v[132:135], v[124:127], 0
    s_waitcnt vmcnt(1)
    v_mov_b32 v13, 1
    v_lshlrev_b32 v5, 7, v1
    s_mov_b64 exec, 127
    buffer_atomic_add v13, v5, s[60:63], s76 offen
    s_mov_b64 exec, -1
    s_setprio 0
    s_load_dword s16, s[40:41], s34 offset:0 glc
    s_mov_b32 s100, 20000
L_poll28:
    s_waitcnt lgkmcnt(0)
    s_cmp_eq_u32 s16, 6
    s_nop 0
    s_cbranch_scc1 L_polld29
    s_sub_u32 s100, s100, 1
    s_cbranch_scc1 L_polld29
    s_sleep 2
    s_load_dword s16, s[40:41], s34 offset:0 glc
    s_branch L_poll28
L_polld29:
    s_add_u32 s97, s9, 0
    buffer_load_dwordx4 v[152:155], v2, s[60:63], s97 offen offset:0 sc1
    buffer_load_dwordx4 v[156:159], v7, s[60:63], s97 offen offset:0 sc1
    buffer_load_dwordx4 v[160:163], v2, s[60:63], s97 offen offset:1024 sc1
    buffer_load_dwordx4 v[164:167], v7, s[60:63], s97 offen offset:1024 sc1
    buffer_load_dwordx4 v[168:171], v2, s[60:63], s97 offen offset:2048 sc1
    buffer_load_dwordx4 v[172:175], v7, s[60:63], s97 offen offset:2048 sc1
    buffer_load_dwordx4 v[176:179], v2, s[60:63], s97 offen offset:3072 sc1
    buffer_load_dwordx4 v[180:183], v7, s[60:63], s97 offen offset:3072 sc1
    s_add_u32 s97, s9, 8192
    buffer_load_dwordx4 v[184:187], v2, s[60:63], s97 offen offset:0 sc1
    buffer_load_dwordx4 v[188:191], v7, s[60:63], s97 offen offset:0 sc1
    buffer_load_dwordx4 v[192:195], v2, s[60:63], s97 offen offset:1024 sc1
    buffer_load_dwordx4 v[196:199], v7, s[60:63], s97 offen offset:1024 sc1
    buffer_load_dwordx4 v[200:203], v2, s[60:63], s97 offen offset:2048 sc1
    buffer_load_dwordx4 v[204:207], v7, s[60:63], s97 offen offset:2048 sc1
    buffer_load_dwordx4 v[208:211], v2, s[60:63], s97 offen offset:3072 sc1
    buffer_load_dwordx4 v[212:215], v7, s[60:63], s97 offen offset:3072 sc1
    s_mov_b32 s100, 160000
L_aw30:
    ds_read_b32 v13, v6 offset:32
    s_waitcnt lgkmcnt(0)
    v_cmp_ne_u32 vcc, 4, v13
    s_nop 4
    s_cbranch_vccz L_awd31
    s_sub_u32 s100, s100, 1
    s_cbranch_scc0 L_aw30
L_awd31:
    ds_read_b64_tr_b16 v[88:89], v14 offset:0
    ds_read_b64_tr_b16 v[90:91], v14 offset:1024
    ds_read_b64_tr_b16 v[92:93], v15 offset:0
    ds_read_b64_tr_b16 v[94:95], v15 offset:1024
    ds_read_b64_tr_b16 v[96:97], v14 offset:2048
    ds_read_b64_tr_b16 v[98:99], v14 offset:3072
    ds_read_b64_tr_b16 v[100:101], v15 offset:2048
    ds_read_b64_tr_b16 v[102:103], v15 offset:3072
    ds_read_b64_tr_b16 v[104:105], v14 offset:4096
    ds_read_b64_tr_b16 v[106:107], v14 offset:5120
    ds_read_b64_tr_b16 v[108:109], v15 offset:4096
    ds_read_b64_tr_b16 v[110:111], v15 offset:5120
    s_waitcnt lgkmcnt(8)
    ds_read_b64_tr_b16 v[112:113], v14 offset:6144
    ds_read_b64_tr_b16 v[114:115], v14 offset:7168
    ds_read_b64_tr_b16 v[116:117], v15 offset:6144
    ds_read_b64_tr_b16 v[118:119], v15 offset:7168
    s_waitcnt lgkmcnt(0)
    s_add_u32 s95, s10, 229376
    s_add_u32 m0, s14, 0
    s_nop 0
    buffer_load_dwordx4 v18, s[52:55], s95 offen offset:0 lds
    ds_read_b64_tr_b16 v[120:121], v14 offset:32768
    ds_read_b64_tr_b16 v[122:123], v14 offset:33792
    ds_read_b64_tr_b16 v[124:125], v15 offset:32768
    ds_read_b64_tr_b16 v[126:127], v15 offset:33792
    buffer_load_dwordx4 v19, s[52:55], s95 offen offset:1024 lds
    ds_read_b64_tr_b16 v[128:129], v14 offset:34816
    ds_read_b64_tr_b16 v[130:131], v14 offset:35840
    ds_read_b64_tr_b16 v[132:133], v15 offset:34816
    ds_read_b64_tr_b16 v[134:135], v15 offset:35840
    buffer_load_dwordx4 v20, s[52:55], s95 offen offset:2048 lds
    ds_read_b64_tr_b16 v[136:137], v14 offset:36864
    ds_read_b64_tr_b16 v[138:139], v14 offset:37888
    ds_read_b64_tr_b16 v[140:141], v15 offset:36864
    ds_read_b64_tr_b16 v[142:143], v15 offset:37888
    buffer_load_dwordx4 v21, s[52:55], s95 offen offset:3072 lds
    s_waitcnt lgkmcnt(8)
    ds_read_b64_tr_b16 v[144:145], v14 offset:38912
    ds_read_b64_tr_b16 v[146:147], v14 offset:39936
    ds_read_b64_tr_b16 v[148:149], v15 offset:38912
    ds_read_b64_tr_b16 v[150:151], v15 offset:39936
    s_add_u32 s95, s10, 258048
    s_add_u32 m0, s14, 4096
    s_nop 0
    buffer_load_dwordx4 v18, s[52:55], s95 offen offset:0 lds
    buffer_load_dwordx4 v19, s[52:55], s95 offen offset:1024 lds
    buffer_load_dwordx4 v20, s[52:55], s95 offen offset:2048 lds
    buffer_load_dwordx4 v21, s[52:55], s95 offen offset:3072 lds
    s_waitcnt lgkmcnt(0)
    s_load_dword s16, s[40:41], s34 offset:1024 glc
    s_waitcnt vmcnt(22)
    v_mfma_f32_32x32x16_bf16 v[24:39], v[88:91], v[152:155], v[24:39]
    s_add_u32 s97, s9, 16384
    buffer_load_dwordx4 v[216:219], v2, s[60:63], s97 offen offset:0 sc1
    buffer_load_dwordx4 v[220:223], v7, s[60:63], s97 offen offset:0 sc1
    v_mfma_f32_32x32x16_bf16 v[40:55], v[92:95], v[152:155], v[40:55]
    buffer_load_dwordx4 v[224:227], v2, s[60:63], s97 offen offset:1024 sc1
    buffer_load_dwordx4 v[228:231], v7, s[60:63], s97 offen offset:1024 sc1
    v_mfma_f32_32x32x16_bf16 v[56:71], v[88:91], v[156:159], v[56:71]
    buffer_load_dwordx4 v[232:235], v2, s[60:63], s97 offen offset:2048 sc1
    buffer_load_dwordx4 v[236:239], v7, s[60:63], s97 offen offset:2048 sc1
    v_mfma_f32_32x32x16_bf16 v[72:87], v[92:95], v[156:159], v[72:87]
    buffer_load_dwordx4 v[240:243], v2, s[60:63], s97 offen offset:3072 sc1
    buffer_load_dwordx4 v[244:247], v7, s[60:63], s97 offen offset:3072 sc1
    s_waitcnt vmcnt(28)
    v_mfma_f32_32x32x16_bf16 v[24:39], v[96:99], v[160:163], v[24:39]
    s_add_u32 s95, s13, 0
    s_add_u32 m0, s14, 32768
    s_nop 0
    buffer_load_dwordx4 v18, s[52:55], s95 offen offset:0 lds
    v_mfma_f32_32x32x16_bf16 v[40:55], v[100:103], v[160:163], v[40:55]
    buffer_load_dwordx4 v19, s[52:55], s95 offen offset:1024 lds
    v_mfma_f32_32x32x16_bf16 v[56:71], v[96:99], v[164:167], v[56:71]
    buffer_load_dwordx4 v20, s[52:55], s95 offen offset:2048 lds
    v_mfma_f32_32x32x16_bf16 v[72:87], v[100:103], v[164:167], v[72:87]
    buffer_load_dwordx4 v21, s[52:55], s95 offen offset:3072 lds
    s_waitcnt vmcnt(30)
    v_mfma_f32_32x32x16_bf16 v[24:39], v[104:107], v[168:171], v[24:39]
    s_add_u32 s95, s13, 28672
    s_add_u32 m0, s14, 36864
    s_nop 0
    buffer_load_dwordx4 v18, s[52:55], s95 offen offset:0 lds
    v_mfma_f32_32x32x16_bf16 v[40:55], v[108:111], v[168:171], v[40:55]
    buffer_load_dwordx4 v19, s[52:55], s95 offen offset:1024 lds
    v_mfma_f32_32x32x16_bf16 v[56:71], v[104:107], v[172:175], v[56:71]
    buffer_load_dwordx4 v20, s[52:55], s95 offen offset:2048 lds
    v_mfma_f32_32x32x16_bf16 v[72:87], v[108:111], v[172:175], v[72:87]
    buffer_load_dwordx4 v21, s[52:55], s95 offen offset:3072 lds
    s_mov_b32 s100, 20000
L_poll32:
    s_waitcnt lgkmcnt(0)
    s_cmp_eq_u32 s16, 8
    s_nop 7
    s_cbranch_scc1 L_polld33
    s_sub_u32 s100, s100, 1
    s_cbranch_scc1 L_polld33
    s_sleep 2
    s_load_dword s16, s[40:41], s34 offset:1024 glc
    s_branch L_poll32
L_polld33:
    s_waitcnt vmcnt(32)
    v_mfma_f32_32x32x16_bf16 v[24:39], v[112:115], v[176:179], v[24:39]
    s_add_u32 s97, s12, 0
    buffer_load_dwordx4 v[248:251], v2, s[60:63], s97 offen offset:0 sc1
    v_mfma_f32_32x32x16_bf16 v[40:55], v[116:119], v[176:179], v[40:55]
    buffer_load_dwordx4 v[252:255], v7, s[60:63], s97 offen offset:0 sc1
    v_mfma_f32_32x32x16_bf16 v[56:71], v[112:115], v[180:183], v[56:71]
    buffer_load_dwordx4 v[152:155], v2, s[60:63], s97 offen offset:1024 sc1
    v_mfma_f32_32x32x16_bf16 v[72:87], v[116:119], v[180:183], v[72:87]
    buffer_load_dwordx4 v[156:159], v7, s[60:63], s97 offen offset:1024 sc1
    s_waitcnt vmcnt(34)
    v_mfma_f32_32x32x16_bf16 v[24:39], v[120:123], v[184:187], v[24:39]
    buffer_load_dwordx4 v[160:163], v2, s[60:63], s97 offen offset:2048 sc1
    v_mfma_f32_32x32x16_bf16 v[40:55], v[124:127], v[184:187], v[40:55]
    buffer_load_dwordx4 v[164:167], v7, s[60:63], s97 offen offset:2048 sc1
    v_mfma_f32_32x32x16_bf16 v[56:71], v[120:123], v[188:191], v[56:71]
    buffer_load_dwordx4 v[168:171], v2, s[60:63], s97 offen offset:3072 sc1
    v_mfma_f32_32x32x16_bf16 v[72:87], v[124:127], v[188:191], v[72:87]
    buffer_load_dwordx4 v[172:175], v7, s[60:63], s97 offen offset:3072 sc1
    s_waitcnt vmcnt(36)
    v_mfma_f32_32x32x16_bf16 v[24:39], v[128:131], v[192:195], v[24:39]
    s_waitcnt vmcnt(24)
    ds_read_b64_tr_b16 v[88:89], v14 offset:0
    ds_read_b64_tr_b16 v[90:91], v14 offset:1024
    s_add_u32 s97, s9, 4096
    buffer_load_dwordx4 v[176:179], v2, s[60:63], s97 offen offset:0 sc1
    v_mfma_f32_32x32x16_bf16 v[40:55], v[132:135], v[192:195], v[40:55]
    ds_read_b64_tr_b16 v[92:93], v15 offset:0
    ds_read_b64_tr_b16 v[94:95], v15 offset:1024
    buffer_load_dwordx4 v[180:183], v7, s[60:63], s97 offen offset:0 sc1
    v_mfma_f32_32x32x16_bf16 v[56:71], v[128:131], v[196:199], v[56:71]
    buffer_load_dwordx4 v[184:187], v2, s[60:63], s97 offen offset:1024 sc1
    v_mfma_f32_32x32x16_bf16 v[72:87], v[132:135], v[196:199], v[72:87]
    buffer_load_dwordx4 v[188:191], v7, s[60:63], s97 offen offset:1024 sc1
    s_waitcnt vmcnt(38)
    v_mfma_f32_32x32x16_bf16 v[24:39], v[136:139], v[200:203], v[24:39]
    ds_read_b64_tr_b16 v[96:97], v14 offset:2048
    ds_read_b64_tr_b16 v[98:99], v14 offset:3072
    buffer_load_dwordx4 v[192:195], v2, s[60:63], s97 offen offset:2048 sc1
    v_mfma_f32_32x32x16_bf16 v[40:55], v[140:143], v[200:203], v[40:55]
    ds_read_b64_tr_b16 v[100:101], v15 offset:2048
    ds_read_b64_tr_b16 v[102:103], v15 offset:3072
    buffer_load_dwordx4 v[196:199], v7, s[60:63], s97 offen offset:2048 sc1
    v_mfma_f32_32x32x16_bf16 v[56:71], v[136:139], v[204:207], v[56:71]
    v_mfma_f32_32x32x16_bf16 v[72:87], v[140:143], v[204:207], v[72:87]
    s_waitcnt vmcnt(38)
    v_mfma_f32_32x32x16_bf16 v[24:39], v[144:147], v[208:211], v[24:39]
    ds_read_b64_tr_b16 v[104:105], v14 offset:4096
    ds_read_b64_tr_b16 v[106:107], v14 offset:5120
    buffer_load_dwordx4 v[200:203], v2, s[60:63], s97 offen offset:3072 sc1
    v_mfma_f32_32x32x16_bf16 v[40:55], v[148:151], v[208:211], v[40:55]
    ds_read_b64_tr_b16 v[108:109], v15 offset:4096
    ds_read_b64_tr_b16 v[110:111], v15 offset:5120
    buffer_load_dwordx4 v[204:207], v7, s[60:63], s97 offen offset:3072 sc1
    v_mfma_f32_32x32x16_bf16 v[56:71], v[144:147], v[212:215], v[56:71]
    v_mfma_f32_32x32x16_bf16 v[72:87], v[148:151], v[212:215], v[72:87]
    s_waitcnt vmcnt(30)
    s_waitcnt lgkmcnt(8)
    v_mfma_f32_32x32x16_bf16 v[24:39], v[88:91], v[216:219], v[24:39]
    ds_read_b64_tr_b16 v[112:113], v14 offset:6144
    ds_read_b64_tr_b16 v[114:115], v14 offset:7168
    s_add_u32 s97, s9, 12288
    buffer_load_dwordx4 v[208:211], v2, s[60:63], s97 offen offset:0 sc1
    v_mfma_f32_32x32x16_bf16 v[40:55], v[92:95], v[216:219], v[40:55]
    ds_read_b64_tr_b16 v[116:117], v15 offset:6144
    ds_read_b64_tr_b16 v[118:119], v15 offset:7168
    buffer_load_dwordx4 v[212:215], v7, s[60:63], s97 offen offset:0 sc1
    v_mfma_f32_32x32x16_bf16 v[56:71], v[88:91], v[220:223], v[56:71]
    v_mfma_f32_32x32x16_bf16 v[72:87], v[92:95], v[220:223], v[72:87]
    s_waitcnt vmcnt(30)
    s_waitcnt lgkmcnt(8)
    v_mfma_f32_32x32x16_bf16 v[24:39], v[96:99], v[224:227], v[24:39]
    s_waitcnt vmcnt(18)
    ds_read_b64_tr_b16 v[120:121], v14 offset:32768
    ds_read_b64_tr_b16 v[122:123], v14 offset:33792
    buffer_load_dwordx4 v[216:219], v2, s[60:63], s97 offen offset:1024 sc1
    v_mfma_f32_32x32x16_bf16 v[40:55], v[100:103], v[224:227], v[40:55]
    ds_read_b64_tr_b16 v[124:125], v15 offset:32768
    ds_read_b64_tr_b16 v[126:127], v15 offset:33792
    buffer_load_dwordx4 v[220:223], v7, s[60:63], s97 offen offset:1024 sc1
    v_mfma_f32_32x32x16_bf16 v[56:71], v[96:99], v[228:231], v[56:71]
    v_mfma_f32_32x32x16_bf16 v[72:87], v[100:103], v[228:231], v[72:87]
    s_waitcnt vmcnt(30)
    s_waitcnt lgkmcnt(8)
    v_mfma_f32_32x32x16_bf16 v[24:39], v[104:107], v[232:235], v[24:39]
    ds_read_b64_tr_b16 v[128:129], v14 offset:34816
    ds_read_b64_tr_b16 v[130:131], v14 offset:35840
    buffer_load_dwordx4 v[224:227], v2, s[60:63], s97 offen offset:2048 sc1
    v_mfma_f32_32x32x16_bf16 v[40:55], v[108:111], v[232:235], v[40:55]
    ds_read_b64_tr_b16 v[132:133], v15 offset:34816
    ds_read_b64_tr_b16 v[134:135], v15 offset:35840
    buffer_load_dwordx4 v[228:231], v7, s[60:63], s97 offen offset:2048 sc1
    v_mfma_f32_32x32x16_bf16 v[56:71], v[104:107], v[236:239], v[56:71]
    v_mfma_f32_32x32x16_bf16 v[72:87], v[108:111], v[236:239], v[72:87]
    s_mov_b32 s100, 160000
    s_nop 10
L_aw34:
    ds_read_b32 v13, v6 offset:16
    s_waitcnt lgkmcnt(0)
    v_cmp_ne_u32 vcc, 4, v13
    s_nop 4
    s_cbranch_vccz L_awd35
    s_sub_u32 s100, s100, 1
    s_cbranch_scc0 L_aw34
L_awd35:
    s_waitcnt vmcnt(30)
    s_waitcnt lgkmcnt(9)
    v_mfma_f32_32x32x16_bf16 v[24:39], v[112:115], v[240:243], v[24:39]
    ds_read_b64_tr_b16 v[136:137], v14 offset:36864
    ds_read_b64_tr_b16 v[138:139], v14 offset:37888
    s_add_u32 s95, s10, 57344
    s_add_u32 m0, s14, 98304
    s_nop 0
    buffer_load_dwordx4 v18, s[52:55], s95 offen offset:0 lds
    buffer_load_dwordx4 v19, s[52:55], s95 offen offset:1024 lds
    v_mfma_f32_32x32x16_bf16 v[40:55], v[116:119], v[240:243], v[40:55]
    ds_read_b64_tr_b16 v[140:141], v15 offset:36864
    ds_read_b64_tr_b16 v[142:143], v15 offset:37888
    buffer_load_dwordx4 v20, s[52:55], s95 offen offset:2048 lds
    v_mfma_f32_32x32x16_bf16 v[56:71], v[112:115], v[244:247], v[56:71]
    buffer_load_dwordx4 v21, s[52:55], s95 offen offset:3072 lds
    v_mfma_f32_32x32x16_bf16 v[72:87], v[116:119], v[244:247], v[72:87]
    s_add_u32 s95, s10, 86016
    s_add_u32 m0, s14, 102400
    s_nop 0
    buffer_load_dwordx4 v18, s[52:55], s95 offen offset:0 lds
    s_waitcnt lgkmcnt(13)
    s_waitcnt vmcnt(25)
    s_waitcnt lgkmcnt(9)
    v_mfma_f32_32x32x16_bf16 v[24:39], v[120:123], v[248:251], v[24:39]
    ds_read_b64_tr_b16 v[144:145], v14 offset:38912
    ds_read_b64_tr_b16 v[146:147], v14 offset:39936
    buffer_load_dwordx4 v19, s[52:55], s95 offen offset:1024 lds
    buffer_load_dwordx4 v20, s[52:55], s95 offen offset:2048 lds
    v_mfma_f32_32x32x16_bf16 v[40:55], v[124:127], v[248:251], v[40:55]
    ds_read_b64_tr_b16 v[148:149], v15 offset:38912
    ds_read_b64_tr_b16 v[150:151], v15 offset:39936
    buffer_load_dwordx4 v21, s[52:55], s95 offen offset:3072 lds
    buffer_load_dwordx4 v[232:235], v2, s[60:63], s97 offen offset:3072 sc1
    v_mfma_f32_32x32x16_bf16 v[56:71], v[120:123], v[252:255], v[56:71]
    buffer_load_dwordx4 v[236:239], v7, s[60:63], s97 offen offset:3072 sc1
    s_add_u32 s97, s9, 20480
    buffer_load_dwordx4 v[240:243], v2, s[60:63], s97 offen offset:0 sc1
    v_mfma_f32_32x32x16_bf16 v[72:87], v[124:127], v[252:255], v[72:87]
    buffer_load_dwordx4 v[244:247], v7, s[60:63], s97 offen offset:0 sc1
    s_add_u32 s95, s10, 172032
    s_add_u32 m0, s14, 0
    s_nop 0
    buffer_load_dwordx4 v18, s[52:55], s95 offen offset:0 lds
    s_waitcnt vmcnt(31)
    s_waitcnt lgkmcnt(9)
    v_mfma_f32_32x32x16_bf16 v[24:39], v[128:131], v[152:155], v[24:39]
    s_waitcnt vmcnt(5)
    ds_read_b64_tr_b16 v[88:89], v16 offset:32768
    ds_read_b64_tr_b16 v[90:91], v16 offset:33792
    buffer_load_dwordx4 v19, s[52:55], s95 offen offset:1024 lds
    buffer_load_dwordx4 v20, s[52:55], s95 offen offset:2048 lds
    v_mfma_f32_32x32x16_bf16 v[40:55], v[132:135], v[152:155], v[40:55]
    ds_read_b64_tr_b16 v[92:93], v17 offset:32768
    ds_read_b64_tr_b16 v[94:95], v17 offset:33792
    buffer_load_dwordx4 v21, s[52:55], s95 offen offset:3072 lds
    v_mfma_f32_32x32x16_bf16 v[56:71], v[128:131], v[156:159], v[56:71]
    s_add_u32 s95, s10, 200704
    s_add_u32 m0, s14, 4096
    s_nop 0
    buffer_load_dwordx4 v18, s[52:55], s95 offen offset:0 lds
    v_mfma_f32_32x32x16_bf16 v[72:87], v[132:135], v[156:159], v[72:87]
    buffer_load_dwordx4 v19, s[52:55], s95 offen offset:1024 lds
    s_waitcnt vmcnt(34)
    s_waitcnt lgkmcnt(8)
    v_mfma_f32_32x32x16_bf16 v[24:39], v[136:139], v[160:163], v[24:39]
    ds_read_b64_tr_b16 v[96:97], v16 offset:34816
    ds_read_b64_tr_b16 v[98:99], v16 offset:35840
    buffer_load_dwordx4 v20, s[52:55], s95 offen offset:2048 lds
    v_mfma_f32_32x32x16_bf16 v[40:55], v[140:143], v[160:163], v[40:55]
    ds_read_b64_tr_b16 v[100:101], v17 offset:34816
    ds_read_b64_tr_b16 v[102:103], v17 offset:35840
    buffer_load_dwordx4 v21, s[52:55], s95 offen offset:3072 lds
    v_mfma_f32_32x32x16_bf16 v[56:71], v[136:139], v[164:167], v[56:71]
    buffer_load_dwordx4 v[248:251], v2, s[60:63], s97 offen offset:1024 sc1
    v_mfma_f32_32x32x16_bf16 v[72:87], v[140:143], v[164:167], v[72:87]
    buffer_load_dwordx4 v[252:255], v7, s[60:63], s97 offen offset:1024 sc1
    s_waitcnt vmcnt(36)
    s_waitcnt lgkmcnt(8)
    v_mfma_f32_32x32x16_bf16 v[24:39], v[144:147], v[168:171], v[24:39]
    ds_read_b64_tr_b16 v[104:105], v16 offset:36864
    ds_read_b64_tr_b16 v[106:107], v16 offset:37888
    buffer_load_dwordx4 v[152:155], v2, s[60:63], s97 offen offset:2048 sc1
    v_mfma_f32_32x32x16_bf16 v[40:55], v[148:151], v[168:171], v[40:55]
    ds_read_b64_tr_b16 v[108:109], v17 offset:36864
    ds_read_b64_tr_b16 v[110:111], v17 offset:37888
    buffer_load_dwordx4 v[156:159], v7, s[60:63], s97 offen offset:2048 sc1
    v_mfma_f32_32x32x16_bf16 v[56:71], v[144:147], v[172:175], v[56:71]
    buffer_load_dwordx4 v[160:163], v2, s[60:63], s97 offen offset:3072 sc1
    v_mfma_f32_32x32x16_bf16 v[72:87], v[148:151], v[172:175], v[72:87]
    buffer_load_dwordx4 v[164:167], v7, s[60:63], s97 offen offset:3072 sc1
    s_waitcnt lgkmcnt(12)
    s_waitcnt vmcnt(38)
    s_waitcnt lgkmcnt(8)
    v_mfma_f32_32x32x16_bf16 v[24:39], v[88:91], v[176:179], v[24:39]
    ds_read_b64_tr_b16 v[112:113], v16 offset:38912
    ds_read_b64_tr_b16 v[114:115], v16 offset:39936
    s_add_u32 s95, s10, 286720
    s_add_u32 m0, s14, 32768
    s_nop 0
    buffer_load_dwordx4 v18, s[52:55], s95 offen offset:0 lds
    v_mfma_f32_32x32x16_bf16 v[40:55], v[92:95], v[176:179], v[40:55]
    ds_read_b64_tr_b16 v[116:117], v17 offset:38912
    ds_read_b64_tr_b16 v[118:119], v17 offset:39936
    buffer_load_dwordx4 v19, s[52:55], s95 offen offset:1024 lds
    v_mfma_f32_32x32x16_bf16 v[56:71], v[88:91], v[180:183], v[56:71]
    buffer_load_dwordx4 v20, s[52:55], s95 offen offset:2048 lds
    v_mfma_f32_32x32x16_bf16 v[72:87], v[92:95], v[180:183], v[72:87]
    buffer_load_dwordx4 v21, s[52:55], s95 offen offset:3072 lds
    s_waitcnt vmcnt(40)
    s_waitcnt lgkmcnt(8)
    v_mfma_f32_32x32x16_bf16 v[24:39], v[96:99], v[184:187], v[24:39]
    s_waitcnt vmcnt(10)
    ds_read_b64_tr_b16 v[120:121], v14 offset:0
    ds_read_b64_tr_b16 v[122:123], v14 offset:1024
    s_add_u32 s95, s10, 315392
    s_add_u32 m0, s14, 36864
    s_nop 0
    buffer_load_dwordx4 v18, s[52:55], s95 offen offset:0 lds
    v_mfma_f32_32x32x16_bf16 v[40:55], v[100:103], v[184:187], v[40:55]
    ds_read_b64_tr_b16 v[124:125], v15 offset:0
    ds_read_b64_tr_b16 v[126:127], v15 offset:1024
    buffer_load_dwordx4 v19, s[52:55], s95 offen offset:1024 lds
    v_mfma_f32_32x32x16_bf16 v[56:71], v[96:99], v[188:191], v[56:71]
    buffer_load_dwordx4 v20, s[52:55], s95 offen offset:2048 lds
    v_mfma_f32_32x32x16_bf16 v[72:87], v[100:103], v[188:191], v[72:87]
    buffer_load_dwordx4 v21, s[52:55], s95 offen offset:3072 lds
    s_waitcnt vmcnt(42)
    s_waitcnt lgkmcnt(8)
    v_mfma_f32_32x32x16_bf16 v[24:39], v[104:107], v[192:195], v[24:39]
    ds_read_b64_tr_b16 v[128:129], v14 offset:2048
    ds_read_b64_tr_b16 v[130:131], v14 offset:3072
    v_mfma_f32_32x32x16_bf16 v[40:55], v[108:111], v[192:195], v[40:55]
    ds_read_b64_tr_b16 v[132:133], v15 offset:2048
    ds_read_b64_tr_b16 v[134:135], v15 offset:3072
    v_mfma_f32_32x32x16_bf16 v[56:71], v[104:107], v[196:199], v[56:71]
    v_mfma_f32_32x32x16_bf16 v[72:87], v[108:111], v[196:199], v[72:87]
    s_waitcnt vmcnt(40)
    s_waitcnt lgkmcnt(8)
    v_mfma_f32_32x32x16_bf16 v[24:39], v[112:115], v[200:203], v[24:39]
    ds_read_b64_tr_b16 v[136:137], v14 offset:4096
    ds_read_b64_tr_b16 v[138:139], v14 offset:5120
    v_mfma_f32_32x32x16_bf16 v[40:55], v[116:119], v[200:203], v[40:55]
    ds_read_b64_tr_b16 v[140:141], v15 offset:4096
    ds_read_b64_tr_b16 v[142:143], v15 offset:5120
    v_mfma_f32_32x32x16_bf16 v[56:71], v[112:115], v[204:207], v[56:71]
    v_mfma_f32_32x32x16_bf16 v[72:87], v[116:119], v[204:207], v[72:87]
    s_mov_b32 s100, 160000
    s_nop 10
L_aw36:
    ds_read_b32 v13, v6 offset:24
    s_waitcnt lgkmcnt(0)
    v_cmp_ne_u32 vcc, 4, v13
    s_nop 4
    s_cbranch_vccz L_awd37
    s_sub_u32 s100, s100, 1
    s_cbranch_scc0 L_aw36
L_awd37:
    s_waitcnt lgkmcnt(13)
    s_waitcnt vmcnt(38)
    s_waitcnt lgkmcnt(9)
    v_mfma_f32_32x32x16_bf16 v[24:39], v[120:123], v[208:211], v[24:39]
    ds_read_b64_tr_b16 v[144:145], v14 offset:6144
    ds_read_b64_tr_b16 v[146:147], v14 offset:7168
    s_mul_i32 s95, s75, 100352
    s_lshl_b32 s96, s43, 7
    s_add_u32 s95, s95, s96
    s_add_u32 m0, s14, 65536
    s_nop 0
    buffer_load_dwordx4 v18, s[56:59], s95 offen offset:0 lds
    buffer_load_dwordx4 v19, s[56:59], s95 offen offset:1024 lds
    v_mfma_f32_32x32x16_bf16 v[40:55], v[124:127], v[208:211], v[40:55]
    ds_read_b64_tr_b16 v[148:149], v15 offset:6144
    ds_read_b64_tr_b16 v[150:151], v15 offset:7168
    buffer_load_dwordx4 v20, s[56:59], s95 offen offset:2048 lds
    buffer_load_dwordx4 v21, s[56:59], s95 offen offset:3072 lds
    v_mfma_f32_32x32x16_bf16 v[56:71], v[120:123], v[212:215], v[56:71]
    s_add_u32 s95, s95, 28672
    s_add_u32 m0, s14, 69632
    s_nop 0
    buffer_load_dwordx4 v18, s[56:59], s95 offen offset:0 lds
    buffer_load_dwordx4 v19, s[56:59], s95 offen offset:1024 lds
    v_mfma_f32_32x32x16_bf16 v[72:87], v[124:127], v[212:215], v[72:87]
    buffer_load_dwordx4 v20, s[56:59], s95 offen offset:2048 lds
    s_waitcnt vmcnt(43)
    s_waitcnt lgkmcnt(9)
    v_mfma_f32_32x32x16_bf16 v[24:39], v[128:131], v[216:219], v[24:39]
    s_waitcnt vmcnt(7)
    ds_read_b64_tr_b16 v[88:89], v14 offset:32768
    ds_read_b64_tr_b16 v[90:91], v14 offset:33792
    s_mul_i32 s95, s75, 100352
    s_lshl_b32 s96, s43, 7
    s_add_u32 s95, s95, s96
    s_add_u32 s95, s95, 50176
    s_add_u32 m0, s14, 98304
    s_nop 0
    buffer_load_dwordx4 v18, s[56:59], s95 offen offset:0 lds
    v_mfma_f32_32x32x16_bf16 v[40:55], v[132:135], v[216:219], v[40:55]
    ds_read_b64_tr_b16 v[92:93], v15 offset:32768
    ds_read_b64_tr_b16 v[94:95], v15 offset:33792
    buffer_load_dwordx4 v19, s[56:59], s95 offen offset:1024 lds
    v_mfma_f32_32x32x16_bf16 v[56:71], v[128:131], v[220:223], v[56:71]
    buffer_load_dwordx4 v20, s[56:59], s95 offen offset:2048 lds
    v_mfma_f32_32x32x16_bf16 v[72:87], v[132:135], v[220:223], v[72:87]
    buffer_load_dwordx4 v21, s[56:59], s95 offen offset:3072 lds
    s_waitcnt vmcnt(45)
    s_waitcnt lgkmcnt(9)
    v_mfma_f32_32x32x16_bf16 v[24:39], v[136:139], v[224:227], v[24:39]
    ds_read_b64_tr_b16 v[96:97], v14 offset:34816
    ds_read_b64_tr_b16 v[98:99], v14 offset:35840
    s_add_u32 s95, s95, 28672
    s_add_u32 m0, s14, 102400
    s_nop 0
    buffer_load_dwordx4 v18, s[56:59], s95 offen offset:0 lds
    v_mfma_f32_32x32x16_bf16 v[40:55], v[140:143], v[224:227], v[40:55]
    ds_read_b64_tr_b16 v[100:101], v15 offset:34816
    ds_read_b64_tr_b16 v[102:103], v15 offset:35840
    buffer_load_dwordx4 v19, s[56:59], s95 offen offset:1024 lds
    v_mfma_f32_32x32x16_bf16 v[56:71], v[136:139], v[228:231], v[56:71]
    buffer_load_dwordx4 v20, s[56:59], s95 offen offset:2048 lds
    v_mfma_f32_32x32x16_bf16 v[72:87], v[140:143], v[228:231], v[72:87]
    s_load_dword s16, s[40:41], s38 offset:0 glc
    s_waitcnt vmcnt(38)
    s_waitcnt lgkmcnt(8)
    v_mfma_f32_32x32x16_bf16 v[24:39], v[144:147], v[232:235], v[24:39]
    ds_read_b64_tr_b16 v[104:105], v14 offset:36864
    ds_read_b64_tr_b16 v[106:107], v14 offset:37888
    v_mfma_f32_32x32x16_bf16 v[40:55], v[148:151], v[232:235], v[40:55]
    ds_read_b64_tr_b16 v[108:109], v15 offset:36864
    ds_read_b64_tr_b16 v[110:111], v15 offset:37888
    v_mfma_f32_32x32x16_bf16 v[56:71], v[144:147], v[236:239], v[56:71]
    v_mfma_f32_32x32x16_bf16 v[72:87], v[148:151], v[236:239], v[72:87]
    s_waitcnt vmcnt(36)
    s_waitcnt lgkmcnt(8)
    v_mfma_f32_32x32x16_bf16 v[24:39], v[88:91], v[240:243], v[24:39]
    ds_read_b64_tr_b16 v[112:113], v14 offset:38912
    ds_read_b64_tr_b16 v[114:115], v14 offset:39936
    v_mfma_f32_32x32x16_bf16 v[40:55], v[92:95], v[240:243], v[40:55]
    ds_read_b64_tr_b16 v[116:117], v15 offset:38912
    ds_read_b64_tr_b16 v[118:119], v15 offset:39936
    v_mfma_f32_32x32x16_bf16 v[56:71], v[88:91], v[244:247], v[56:71]
    v_mfma_f32_32x32x16_bf16 v[72:87], v[92:95], v[244:247], v[72:87]
    v_and_b32 v11, 31, v1
    v_lshlrev_b32 v11, 2, v11
    s_lshl_b32 s93, s11, 7
    s_add_u32 s93, s93, 655360
    s_lshl_b32 s94, s11, 11
    s_add_u32 s94, s94, 4718592
    v_add_u32 v7, 32768, v2
    v_add_u32 v18, s14, v2
    v_xor_b32 v19, 64, v18
    v_xor_b32 v20, 128, v18
    v_xor_b32 v21, 192, v18
    s_waitcnt lgkmcnt(0)
    s_cmp_lg_u32 s16, 8
    s_cbranch_scc1 L_olate
    s_waitcnt vmcnt(26)
    s_waitcnt lgkmcnt(8)
    v_mfma_f32_32x32x16_bf16 v[24:39], v[96:99], v[248:251], v[24:39]
    s_waitcnt vmcnt(7)
    ds_read_b64_tr_b16 v[120:121], v16 offset:0
    ds_read_b64_tr_b16 v[122:123], v16 offset:1024
    buffer_load_dword v10, v11, s[60:63], s93 offen sc1
    buffer_load_dword v11, v11, s[60:63], s93 offen offset:2048 sc1
    buffer_load_dwordx4 v[168:171], v2, s[60:63], s94 offen offset:0 sc1
    v_mfma_f32_32x32x16_bf16 v[40:55], v[100:103], v[248:251], v[40:55]
    ds_read_b64_tr_b16 v[124:125], v17 offset:0
    ds_read_b64_tr_b16 v[126:127], v17 offset:1024
    buffer_load_dwordx4 v[172:175], v7, s[60:63], s94 offen offset:0 sc1
    buffer_load_dwordx4 v[176:179], v2, s[60:63], s94 offen offset:1024 sc1
    v_mfma_f32_32x32x16_bf16 v[56:71], v[96:99], v[252:255], v[56:71]
    buffer_load_dwordx4 v[180:183], v7, s[60:63], s94 offen offset:1024 sc1
    buffer_load_dwordx4 v[184:187], v2, s[60:63], s94 offen offset:2048 sc1
    v_mfma_f32_32x32x16_bf16 v[72:87], v[100:103], v[252:255], v[72:87]
    buffer_load_dwordx4 v[188:191], v7, s[60:63], s94 offen offset:2048 sc1
    buffer_load_dwordx4 v[192:195], v2, s[60:63], s94 offen offset:3072 sc1
    s_waitcnt vmcnt(33)
    s_waitcnt lgkmcnt(8)
    v_mfma_f32_32x32x16_bf16 v[24:39], v[104:107], v[152:155], v[24:39]
    ds_read_b64_tr_b16 v[128:129], v16 offset:2048
    ds_read_b64_tr_b16 v[130:131], v22 offset:3072
    buffer_load_dwordx4 v[196:199], v7, s[60:63], s94 offen offset:3072 sc1
    s_add_u32 s94, s94, 4096
    buffer_load_dwordx4 v[200:203], v2, s[60:63], s94 offen offset:0 sc1
    v_mfma_f32_32x32x16_bf16 v[40:55], v[108:111], v[152:155], v[40:55]
    ds_read_b64_tr_b16 v[132:133], v17 offset:2048
    ds_read_b64_tr_b16 v[134:135], v23 offset:3072
    buffer_load_dwordx4 v[204:207], v7, s[60:63], s94 offen offset:0 sc1
    v_mfma_f32_32x32x16_bf16 v[56:71], v[104:107], v[156:159], v[56:71]
    buffer_load_dwordx4 v[208:211], v2, s[60:63], s94 offen offset:1024 sc1
    v_mfma_f32_32x32x16_bf16 v[72:87], v[108:111], v[156:159], v[72:87]
    buffer_load_dwordx4 v[212:215], v7, s[60:63], s94 offen offset:1024 sc1
    s_waitcnt vmcnt(36)
    s_waitcnt lgkmcnt(8)
    v_mfma_f32_32x32x16_bf16 v[24:39], v[112:115], v[160:163], v[24:39]
    ds_read_b64_tr_b16 v[136:137], v16 offset:3584
    ds_read_b64_tr_b16 v[138:139], v16 offset:4608
    buffer_load_dwordx4 v[216:219], v2, s[60:63], s94 offen offset:2048 sc1
    v_mfma_f32_32x32x16_bf16 v[40:55], v[116:119], v[160:163], v[40:55]
    ds_read_b64_tr_b16 v[140:141], v17 offset:3584
    ds_read_b64_tr_b16 v[142:143], v17 offset:4608
    buffer_load_dwordx4 v[220:223], v7, s[60:63], s94 offen offset:2048 sc1
    v_mfma_f32_32x32x16_bf16 v[56:71], v[112:115], v[164:167], v[56:71]
    buffer_load_dwordx4 v[224:227], v2, s[60:63], s94 offen offset:3072 sc1
    v_mfma_f32_32x32x16_bf16 v[72:87], v[116:119], v[164:167], v[72:87]
    buffer_load_dwordx4 v[228:231], v7, s[60:63], s94 offen offset:3072 sc1
    s_nop 10
    s_branch L_ojoin
L_olate:
    s_waitcnt vmcnt(26)
    s_waitcnt lgkmcnt(8)
    v_mfma_f32_32x32x16_bf16 v[24:39], v[96:99], v[248:251], v[24:39]
    s_waitcnt vmcnt(7)
    ds_read_b64_tr_b16 v[120:121], v16 offset:0
    ds_read_b64_tr_b16 v[122:123], v16 offset:1024
    v_mfma_f32_32x32x16_bf16 v[40:55], v[100:103], v[248:251], v[40:55]
    ds_read_b64_tr_b16 v[124:125], v17 offset:0
    ds_read_b64_tr_b16 v[126:127], v17 offset:1024
    v_mfma_f32_32x32x16_bf16 v[56:71], v[96:99], v[252:255], v[56:71]
    v_mfma_f32_32x32x16_bf16 v[72:87], v[100:103], v[252:255], v[72:87]
    s_waitcnt vmcnt(24)
    s_waitcnt lgkmcnt(8)
    v_mfma_f32_32x32x16_bf16 v[24:39], v[104:107], v[152:155], v[24:39]
    ds_read_b64_tr_b16 v[128:129], v16 offset:2048
    ds_read_b64_tr_b16 v[130:131], v22 offset:3072
    v_mfma_f32_32x32x16_bf16 v[40:55], v[108:111], v[152:155], v[40:55]
    ds_read_b64_tr_b16 v[132:133], v17 offset:2048
    ds_read_b64_tr_b16 v[134:135], v23 offset:3072
    v_mfma_f32_32x32x16_bf16 v[56:71], v[104:107], v[156:159], v[56:71]
    v_mfma_f32_32x32x16_bf16 v[72:87], v[108:111], v[156:159], v[72:87]
    s_waitcnt vmcnt(22)
    s_waitcnt lgkmcnt(8)
    v_mfma_f32_32x32x16_bf16 v[24:39], v[112:115], v[160:163], v[24:39]
    ds_read_b64_tr_b16 v[136:137], v16 offset:3584
    ds_read_b64_tr_b16 v[138:139], v16 offset:4608
    v_mfma_f32_32x32x16_bf16 v[40:55], v[116:119], v[160:163], v[40:55]
    ds_read_b64_tr_b16 v[140:141], v17 offset:3584
    ds_read_b64_tr_b16 v[142:143], v17 offset:4608
    v_mfma_f32_32x32x16_bf16 v[56:71], v[112:115], v[164:167], v[56:71]
    v_mfma_f32_32x32x16_bf16 v[72:87], v[116:119], v[164:167], v[72:87]
    s_load_dword s16, s[40:41], s38 offset:0 glc
    s_mov_b32 s100, 20000
L_poll38:
    s_waitcnt lgkmcnt(0)
    s_cmp_eq_u32 s16, 8
    s_nop 7
    s_cbranch_scc1 L_polld39
    s_sub_u32 s100, s100, 1
    s_cbranch_scc1 L_polld39
    s_sleep 2
    s_load_dword s16, s[40:41], s38 offset:0 glc
    s_branch L_poll38
L_polld39:
    buffer_load_dword v10, v11, s[60:63], s93 offen sc1
    buffer_load_dword v11, v11, s[60:63], s93 offen offset:2048 sc1
    buffer_load_dwordx4 v[168:171], v2, s[60:63], s94 offen offset:0 sc1
    buffer_load_dwordx4 v[172:175], v7, s[60:63], s94 offen offset:0 sc1
    buffer_load_dwordx4 v[176:179], v2, s[60:63], s94 offen offset:1024 sc1
    buffer_load_dwordx4 v[180:183], v7, s[60:63], s94 offen offset:1024 sc1
    buffer_load_dwordx4 v[184:187], v2, s[60:63], s94 offen offset:2048 sc1
    buffer_load_dwordx4 v[188:191], v7, s[60:63], s94 offen offset:2048 sc1
    buffer_load_dwordx4 v[192:195], v2, s[60:63], s94 offen offset:3072 sc1
    buffer_load_dwordx4 v[196:199], v7, s[60:63], s94 offen offset:3072 sc1
    s_add_u32 s94, s94, 4096
    buffer_load_dwordx4 v[200:203], v2, s[60:63], s94 offen offset:0 sc1
    buffer_load_dwordx4 v[204:207], v7, s[60:63], s94 offen offset:0 sc1
    buffer_load_dwordx4 v[208:211], v2, s[60:63], s94 offen offset:1024 sc1
    buffer_load_dwordx4 v[212:215], v7, s[60:63], s94 offen offset:1024 sc1
    buffer_load_dwordx4 v[216:219], v2, s[60:63], s94 offen offset:2048 sc1
    buffer_load_dwordx4 v[220:223], v7, s[60:63], s94 offen offset:2048 sc1
    buffer_load_dwordx4 v[224:227], v2, s[60:63], s94 offen offset:3072 sc1
    buffer_load_dwordx4 v[228:231], v7, s[60:63], s94 offen offset:3072 sc1
L_ojoin:
    s_waitcnt vmcnt(16)
    v_sub_f32 v12, 1.0, v10
    v_sub_f32 v13, 1.0, v11
    v_cvt_pk_bf16_f32 v12, v12, v13
    v_and_b32 v13, 0xffff0000, v12
    v_lshlrev_b32 v12, 16, v12
    v_pk_mul_f32 v[24:25], v[24:25], v[12:13] op_sel_hi:[1,0]
    v_pk_mul_f32 v[26:27], v[26:27], v[12:13] op_sel_hi:[1,0]
    v_pk_mul_f32 v[28:29], v[28:29], v[12:13] op_sel_hi:[1,0]
    v_pk_mul_f32 v[30:31], v[30:31], v[12:13] op_sel_hi:[1,0]
    v_pk_mul_f32 v[32:33], v[32:33], v[12:13] op_sel_hi:[1,0]
    v_pk_mul_f32 v[34:35], v[34:35], v[12:13] op_sel_hi:[1,0]
    v_pk_mul_f32 v[36:37], v[36:37], v[12:13] op_sel_hi:[1,0]
    v_pk_mul_f32 v[38:39], v[38:39], v[12:13] op_sel_hi:[1,0]
    v_pk_mul_f32 v[40:41], v[40:41], v[12:13] op_sel_hi:[1,0]
    v_pk_mul_f32 v[42:43], v[42:43], v[12:13] op_sel_hi:[1,0]
    v_pk_mul_f32 v[44:45], v[44:45], v[12:13] op_sel_hi:[1,0]
    v_pk_mul_f32 v[46:47], v[46:47], v[12:13] op_sel_hi:[1,0]
    v_pk_mul_f32 v[48:49], v[48:49], v[12:13] op_sel_hi:[1,0]
    v_pk_mul_f32 v[50:51], v[50:51], v[12:13] op_sel_hi:[1,0]
    v_pk_mul_f32 v[52:53], v[52:53], v[12:13] op_sel_hi:[1,0]
    v_pk_mul_f32 v[54:55], v[54:55], v[12:13] op_sel_hi:[1,0]
    s_waitcnt vmcnt(15)
    s_waitcnt lgkmcnt(8)
    v_mfma_f32_32x32x16_bf16 v[24:39], v[120:123], v[168:171], v[24:39]
    ds_read_b64_tr_b16 v[144:145], v16 offset:5632
    ds_read_b64_tr_b16 v[146:147], v22 offset:6656
    v_mul_f32 v56, v56, v13
    v_mul_f32 v57, v57, v13
    v_mfma_f32_32x32x16_bf16 v[40:55], v[124:127], v[168:171], v[40:55]
    ds_read_b64_tr_b16 v[148:149], v17 offset:5632
    ds_read_b64_tr_b16 v[150:151], v23 offset:6656
    v_mul_f32 v58, v58, v13
    v_mul_f32 v59, v59, v13
    s_waitcnt vmcnt(13)
    s_waitcnt lgkmcnt(8)
    v_mfma_f32_32x32x16_bf16 v[24:39], v[128:131], v[176:179], v[24:39]
    s_waitcnt vmcnt(18)
    ds_read_b64_tr_b16 v[88:89], v16 offset:32768
    ds_read_b64_tr_b16 v[90:91], v16 offset:33792
    v_mul_f32 v60, v60, v13
    v_mul_f32 v61, v61, v13
    v_mfma_f32_32x32x16_bf16 v[40:55], v[132:135], v[176:179], v[40:55]
    ds_read_b64_tr_b16 v[92:93], v17 offset:32768
    ds_read_b64_tr_b16 v[94:95], v17 offset:33792
    v_mul_f32 v62, v62, v13
    v_mul_f32 v63, v63, v13
    s_waitcnt vmcnt(11)
    s_waitcnt lgkmcnt(8)
    v_mfma_f32_32x32x16_bf16 v[24:39], v[136:139], v[184:187], v[24:39]
    ds_read_b64_tr_b16 v[96:97], v16 offset:34816
    ds_read_b64_tr_b16 v[98:99], v22 offset:35840
    v_mul_f32 v64, v64, v13
    v_mul_f32 v65, v65, v13
    v_mfma_f32_32x32x16_bf16 v[40:55], v[140:143], v[184:187], v[40:55]
    ds_read_b64_tr_b16 v[100:101], v17 offset:34816
    ds_read_b64_tr_b16 v[102:103], v23 offset:35840
    v_mul_f32 v66, v66, v13
    v_mul_f32 v67, v67, v13
    s_waitcnt vmcnt(9)
    s_waitcnt lgkmcnt(8)
    v_mfma_f32_32x32x16_bf16 v[24:39], v[144:147], v[192:195], v[24:39]
    ds_read_b64_tr_b16 v[104:105], v16 offset:36352
    ds_read_b64_tr_b16 v[106:107], v16 offset:37376
    v_mul_f32 v68, v68, v13
    v_mul_f32 v69, v69, v13
    v_mfma_f32_32x32x16_bf16 v[40:55], v[148:151], v[192:195], v[40:55]
    ds_read_b64_tr_b16 v[108:109], v17 offset:36352
    ds_read_b64_tr_b16 v[110:111], v17 offset:37376
    v_mul_f32 v70, v70, v13
    v_mul_f32 v71, v71, v13
    s_waitcnt vmcnt(7)
    s_waitcnt lgkmcnt(8)
    v_mfma_f32_32x32x16_bf16 v[24:39], v[88:91], v[200:203], v[24:39]
    ds_read_b64_tr_b16 v[112:113], v16 offset:38400
    ds_read_b64_tr_b16 v[114:115], v22 offset:39424
    v_mul_f32 v72, v72, v13
    v_mul_f32 v73, v73, v13
    v_mfma_f32_32x32x16_bf16 v[40:55], v[92:95], v[200:203], v[40:55]
    ds_read_b64_tr_b16 v[116:117], v17 offset:38400
    ds_read_b64_tr_b16 v[118:119], v23 offset:39424
    v_mul_f32 v74, v74, v13
    v_mul_f32 v75, v75, v13
    s_waitcnt vmcnt(5)
    s_waitcnt lgkmcnt(8)
    v_mfma_f32_32x32x16_bf16 v[24:39], v[96:99], v[208:211], v[24:39]
    v_mul_f32 v76, v76, v13
    v_mul_f32 v77, v77, v13
    v_mfma_f32_32x32x16_bf16 v[40:55], v[100:103], v[208:211], v[40:55]
    v_mul_f32 v78, v78, v13
    v_mul_f32 v79, v79, v13
    s_waitcnt vmcnt(3)
    s_waitcnt lgkmcnt(4)
    v_mfma_f32_32x32x16_bf16 v[24:39], v[104:107], v[216:219], v[24:39]
    v_mul_f32 v80, v80, v13
    v_mul_f32 v81, v81, v13
    v_mfma_f32_32x32x16_bf16 v[40:55], v[108:111], v[216:219], v[40:55]
    v_mul_f32 v82, v82, v13
    v_mul_f32 v83, v83, v13
    s_waitcnt vmcnt(1)
    s_waitcnt lgkmcnt(0)
    v_mfma_f32_32x32x16_bf16 v[24:39], v[112:115], v[224:227], v[24:39]
    v_mul_f32 v84, v84, v13
    v_mul_f32 v85, v85, v13
    v_mfma_f32_32x32x16_bf16 v[40:55], v[116:119], v[224:227], v[40:55]
    v_mul_f32 v86, v86, v13
    v_mul_f32 v87, v87, v13
    s_waitcnt vmcnt(0)
    v_mfma_f32_32x32x16_bf16 v[56:71], v[120:123], v[172:175], v[56:71]
    v_mfma_f32_32x32x16_bf16 v[72:87], v[124:127], v[172:175], v[72:87]
    v_mfma_f32_32x32x16_bf16 v[56:71], v[128:131], v[180:183], v[56:71]
    v_mfma_f32_32x32x16_bf16 v[72:87], v[132:135], v[180:183], v[72:87]
    v_mfma_f32_32x32x16_bf16 v[56:71], v[136:139], v[188:191], v[56:71]
    v_mfma_f32_32x32x16_bf16 v[72:87], v[140:143], v[188:191], v[72:87]
    v_mfma_f32_32x32x16_bf16 v[56:71], v[144:147], v[196:199], v[56:71]
    ds_write_b128 v18, v[24:27] offset:0
    v_mfma_f32_32x32x16_bf16 v[72:87], v[148:151], v[196:199], v[72:87]
    ds_write_b128 v19, v[28:31] offset:1024
    v_mfma_f32_32x32x16_bf16 v[56:71], v[88:91], v[204:207], v[56:71]
    ds_write_b128 v20, v[32:35] offset:2048
    v_mfma_f32_32x32x16_bf16 v[72:87], v[92:95], v[204:207], v[72:87]
    ds_write_b128 v21, v[36:39] offset:3072
    v_mfma_f32_32x32x16_bf16 v[56:71], v[96:99], v[212:215], v[56:71]
    ds_write_b128 v18, v[40:43] offset:4096
    v_mfma_f32_32x32x16_bf16 v[72:87], v[100:103], v[212:215], v[72:87]
    ds_write_b128 v19, v[44:47] offset:5120
    v_mfma_f32_32x32x16_bf16 v[56:71], v[104:107], v[220:223], v[56:71]
    ds_write_b128 v20, v[48:51] offset:6144
    v_mfma_f32_32x32x16_bf16 v[72:87], v[108:111], v[220:223], v[72:87]
    ds_write_b128 v21, v[52:55] offset:7168
    v_mfma_f32_32x32x16_bf16 v[56:71], v[112:115], v[228:231], v[56:71]
    v_mfma_f32_32x32x16_bf16 v[72:87], v[116:119], v[228:231], v[72:87]
    s_nop 10
    ds_write_b128 v18, v[56:59] offset:32768
    ds_write_b128 v19, v[60:63] offset:33792
    ds_write_b128 v20, v[64:67] offset:34816
    ds_write_b128 v21, v[68:71] offset:35840
    ds_write_b128 v18, v[72:75] offset:36864
    ds_write_b128 v19, v[76:79] offset:37888
    ds_write_b128 v20, v[80:83] offset:38912
    ds_write_b128 v21, v[84:87] offset:39936
L_red:
    v_and_b32 v9, 7, v1
    v_lshrrev_b32 v11, 3, v1
    s_lshl_b32 s91, s75, 3
    v_add_u32 v8, s91, v11
    v_and_b32 v10, 3, v1
    v_lshlrev_b32 v10, 2, v10
    v_xor_b32 v8, v8, v10
    v_lshlrev_b32 v8, 4, v8
    v_lshl_add_u32 v8, v9, 10, v8
    s_lshr_b32 s92, s74, 2
    s_lshl_b32 s90, s92, 15
    v_add_u32 v8, s90, v8
    v_mul_u32_u24 v11, 896, v11
    v_lshl_add_u32 v11, v9, 4, v11
    s_lshl_b32 s90, s3, 2
    s_add_u32 s90, s90, s74
    s_mul_i32 s90, s90, 7168
    s_lshl_b32 s91, s43, 7
    s_add_u32 s95, s90, s91
    s_waitcnt lgkmcnt(0)
    s_barrier
    ds_read_b128 v[160:163], v8 offset:0
    ds_read_b128 v[164:167], v8 offset:512
    ds_read_b128 v[168:171], v8 offset:8192
    ds_read_b128 v[172:175], v8 offset:8704
    ds_read_b128 v[176:179], v8 offset:16384
    ds_read_b128 v[180:183], v8 offset:16896
    ds_read_b128 v[184:187], v8 offset:24576
    ds_read_b128 v[188:191], v8 offset:25088
    s_waitcnt lgkmcnt(4)
    v_pk_add_f32 v[160:161], v[160:161], v[168:169]
    v_pk_add_f32 v[162:163], v[162:163], v[170:171]
    v_pk_add_f32 v[164:165], v[164:165], v[172:173]
    v_pk_add_f32 v[166:167], v[166:167], v[174:175]
    s_waitcnt lgkmcnt(0)
    v_pk_add_f32 v[176:177], v[176:177], v[184:185]
    v_pk_add_f32 v[178:179], v[178:179], v[186:187]
    v_pk_add_f32 v[180:181], v[180:181], v[188:189]
    v_pk_add_f32 v[182:183], v[182:183], v[190:191]
    v_pk_add_f32 v[160:161], v[160:161], v[176:177]
    v_pk_add_f32 v[162:163], v[162:163], v[178:179]
    v_pk_add_f32 v[164:165], v[164:165], v[180:181]
    v_pk_add_f32 v[166:167], v[166:167], v[182:183]
    v_cvt_pk_bf16_f32 v160, v160, v161
    v_cvt_pk_bf16_f32 v161, v162, v163
    v_cvt_pk_bf16_f32 v162, v164, v165
    v_cvt_pk_bf16_f32 v163, v166, v167
    buffer_store_dwordx4 v[160:163], v11, s[64:67], s95 offen
    s_xor_b32 s90, s2, 64
    s_or_b32 s90, s90, s74
    s_cmp_lg_u32 s90, 0
    s_cbranch_scc1 L_fin
    s_mov_b32 s90, 0
    s_mov_b64 exec, 1
    buffer_store_dword v4, v1, s[60:63], s90 offen sc1
    s_mov_b64 exec, -1
L_fin:
L_end:
    s_endpgm
.fill (28672 + 8192 * 0 - (L_end - gated_mix__linear_kernel_hedgehog__dense_activation_gelu__prompt_kernel)) / 4, 4, 0xbf800000
.section .rodata,"a"
.p2align 6
.amdhsa_kernel gated_mix__linear_kernel_hedgehog__dense_activation_gelu__prompt_kernel
  .amdhsa_next_free_vgpr 256
  .amdhsa_next_free_sgpr 102
  .amdhsa_accum_offset 256
  .amdhsa_group_segment_fixed_size 0
  .amdhsa_kernarg_size 104
  .amdhsa_user_sgpr_count 2
  .amdhsa_user_sgpr_kernarg_segment_ptr 1
  .amdhsa_system_sgpr_workgroup_id_x 1
.end_amdhsa_kernel
```
